```python
import torch

def _softmax(x, axis=-1):
    return torch.softmax(x, dim=axis)
def _gelu(x):
    return torch.nn.functional.gelu(x, approximate="tanh")
def _silu(x):
    return torch.nn.functional.silu(x)
def _sigmoid(x):
    return torch.sigmoid(x)
def _layernorm(x, axis=-1, eps=1e-5):
    m = x.mean(dim=axis, keepdim=True)
    v = x.var(dim=axis, keepdim=True, unbiased=False)
    return (x - m) / torch.sqrt(v + eps)
def _scatter_add(tgt, idx, src, axis=0):
    return tgt.clone().index_add_(axis, idx, src)
def _segment_sum(src, seg, n):
    out = torch.zeros((n,) + src.shape[1:], dtype=src.dtype)
    return out.index_add_(0, seg, src)
def _pad(x, pw):
    flat = tuple(v for pair in reversed(pw) for v in pair)
    return torch.nn.functional.pad(x, flat)

kernel_name = 'sequential_preLN__sliding_block_cached__dense_activation_squared_relu__decode'

def setup_inputs():

    _w = (lambda a: (lambda t: t.to(torch.bfloat16) if t.is_floating_point() else t)(torch.as_tensor(a)))
    def _A_setup():
        B, Sq, D = 1, 1, 512
        Hq, Hkv, Sk, Dh = 32, 8, 65536, 128
        assert Hq % Hkv == 0, (Hq, Hkv)
        return {
            "x": _w((lambda *s: torch.randn(*s, dtype=torch.bfloat16) * 0.05)(B, Sq, D)),
            "k_cache": _w((lambda *s: torch.randn(*s, dtype=torch.bfloat16) * 3.2)(B, Hkv, Sk, Dh)),
            "v_cache": _w((lambda *s: torch.randn(*s, dtype=torch.bfloat16) * 0.4)(B, Hkv, Sk, Dh)),
            "wq": _w((lambda *s: torch.randn(*s, dtype=torch.bfloat16) * 3.2)(D, Hq * Dh) * (D ** -0.5)),
            "wo": _w((lambda *s: torch.randn(*s, dtype=torch.bfloat16) * 0.4)(Hq * Dh, D) * ((Hq * Dh) ** -0.5)),
        }
    _A_in = _A_setup()

    def _B_setup():
        B, S, D, F = 1, 1, 512, 1792
        return {
            "x": _w((lambda *s: torch.randn(*s, dtype=torch.bfloat16) * 0.05)(B, S, D)),
            "w1": _w((lambda *s: torch.randn(*s, dtype=torch.bfloat16) * 0.05)(D, F)),
            "b1": _w((lambda *s: torch.randn(*s, dtype=torch.bfloat16) * 0.8)(F)),
            "w2": _w((lambda *s: torch.randn(*s, dtype=torch.bfloat16) * 0.05)(F, D)),
            "b2": _w((lambda *s: torch.randn(*s, dtype=torch.bfloat16) * 1.6)(D)),
        }
    _B_in = _B_setup()

    return {
        "A_x": _A_in["x"],
        "A_k_cache": _A_in["k_cache"],
        "A_v_cache": _A_in["v_cache"],
        "A_wq": _A_in["wq"],
        "A_wo": _A_in["wo"],
        "B_x": _B_in["x"],
        "B_w1": _B_in["w1"],
        "B_b1": _B_in["b1"],
        "B_w2": _B_in["w2"],
        "B_b2": _B_in["b2"],
    }

def reference(A_x, A_k_cache, A_v_cache, A_wq, A_wo, B_x, B_w1, B_b1, B_w2, B_b2):
    def _A_ref(x, k_cache, v_cache, wq, wo):
        B, Sq, D = x.shape
        Hq, Dh = 32, 128
        Hkv, Sk = k_cache.shape[1], k_cache.shape[2]
        W = min(4096, max(256, Sk // 4))
        rep = Hq // Hkv
        q = (lambda x, *d: x.permute(*d))((x @ wq).reshape(B, Sq, Hq, Dh), 0, 2, 1, 3)
        k = (lambda x, n, axis: torch.repeat_interleave(x, n, dim=axis))(k_cache[:, :, Sk - W:, :], rep, axis=1)
        v = (lambda x, n, axis: torch.repeat_interleave(x, n, dim=axis))(v_cache[:, :, Sk - W:, :], rep, axis=1)
        scores = torch.einsum("bhqd,bhkd->bhqk", q, k) * (Dh ** -0.5)
        p = _softmax(scores, axis=-1)
        o = torch.einsum("bhqk,bhkd->bhqd", p, v)
        return (lambda x, *d: x.permute(*d))(o, 0, 2, 1, 3).reshape(B, Sq, Hq * Dh) @ wo

    def _B_ref(x, w1, b1, w2, b2):
        h = torch.einsum("bsd,df->bsf", x, w1) + b1
        zero = torch.zeros_like(h)
        r = torch.where(h > zero, h, zero)
        h = r * r
        out = torch.einsum("bsf,fd->bsd", h, w2) + b2
        return out

    x = A_x
    h = x + _A_ref(_layernorm(x, axis=-1), A_k_cache, A_v_cache, A_wq, A_wo)
    h2 = h + _B_ref(_layernorm(h, axis=-1), B_w1, B_b1, B_w2, B_b2)
    return h2
```

```asm
; @launch grid=(256,1,1) block=(576,1,1) lds=155648
.amdgcn_target "amdgcn-amd-amdhsa--gfx950"
.text
.globl sequential_preLN__sliding_block_cached__dense_activation_squared_relu__decode_kernel
.p2align 8
.type sequential_preLN__sliding_block_cached__dense_activation_squared_relu__decode_kernel,@function
sequential_preLN__sliding_block_cached__dense_activation_squared_relu__decode_kernel:
    s_load_dwordx8 s[32:39], s[0:1], 0
    s_cmp_lt_u32 s2, 240
    s_cbranch_scc1 L_npf
    v_cmp_gt_u32 vcc, 92, v0
    s_and_b64 exec, exec, vcc
    s_cbranch_execz L_npf2
    s_getpc_b64 s[16:17]
    v_lshlrev_b32 v3, 7, v0
    global_load_dword v20, v3, s[16:17] offset:512
L_npf2:
    s_mov_b64 exec, -1
L_npf:
    v_lshrrev_b32 v1, 6, v0
    v_and_b32 v0, 63, v0
    s_cmp_ge_u32 s2, 256
    v_readfirstlane_b32 s3, v1
    s_cbranch_scc1 L_end
    s_lshr_b32 s5, s2, 3
    s_and_b32 s4, s2, 7
    s_cselect_b32 s100, s5, 0
    s_and_b32 s18, s3, 3
    s_mov_b32 s10, 0x400000
    s_mov_b32 s11, 0x20000
    v_lshlrev_b32 v2, 4, v0
    v_and_b32 v10, 15, v0
    v_lshrrev_b32 v11, 4, v0
    v_lshrrev_b32 v8, 3, v0
    v_and_b32 v9, 32, v0
    v_and_b32 v3, 0x70, v2
    v_xor_b32 v9, v9, v3
    s_and_b32 s29, s5, 3
    s_mov_b32 s14, 4194304
    s_mov_b32 s15, 0x20000
    s_cmp_lt_u32 s3, 4
    s_cbranch_scc0 L_lw
    s_load_dwordx2 s[8:9], s[0:1], 96
    s_mul_i32 s25, s5, 37
    s_lshr_b32 s25, s25, 8
    s_mul_i32 s24, s25, 7
    s_sub_u32 s24, s5, s24
    s_cmp_ge_u32 s24, 3
    s_addc_u32 s24, s24, 0
    s_cmp_ge_u32 s5, 28
    s_cselect_b32 s25, s29, s25
    s_cselect_b32 s24, 3, s24
    v_lshlrev_b32 v12, 6, v10
    v_lshl_add_u32 v12, v11, 4, v12
    s_lshl_b32 s28, s25, 8
    v_xor_b32 v13, s28, v12
    s_and_b32 s20, s3, 1
    s_lshl_b32 s21, s20, 6
    v_lshl_add_u32 v14, v8, 13, v9
    v_xor_b32 v14, s21, v14
    s_lshl_b32 s26, s25, 20
    s_lshl_b32 s27, s3, 18
    s_add_u32 s26, s26, s27
    s_lshl_b32 s27, s4, 10
    s_add_u32 s26, s26, s27
    s_lshl_b32 s27, s24, 7
    s_add_u32 s26, s26, s27
    s_lshl_b32 m0, s3, 12
    s_lshl_b32 s20, s4, 14
    s_lshl_b32 s21, s25, 12
    s_add_u32 s20, s20, s21
    s_lshl_b32 s21, s24, 9
    s_add_u32 s20, s20, s21
    s_lshl_b32 s21, s3, 7
    s_add_u32 s20, s20, s21
    s_add_u32 s21, s20, 262144
    s_add_u32 s20, s20, 131072
    v_mov_b64 v[4:5], -1
    v_mov_b64 v[6:7], -1
    v_lshlrev_b32 v3, 7, v0
    s_cmp_lg_u32 s3, 0
    s_waitcnt lgkmcnt(0)
    s_cbranch_scc1 L_nx
    global_load_dwordx4 v[16:19], v13, s[32:33]
L_nx:
    s_mov_b32 s12, s38
    s_mov_b32 s13, s39
    buffer_load_dwordx4 v14, s[12:15], s26 offen offset:0 nt lds
    s_add_u32 s26, s26, 64512
    buffer_load_dwordx4 v14, s[12:15], s26 offen offset:1024 nt lds
    s_add_u32 s26, s26, 64512
    buffer_load_dwordx4 v14, s[12:15], s26 offen offset:2048 nt lds
    s_add_u32 s26, s26, 64512
    buffer_load_dwordx4 v14, s[12:15], s26 offen offset:3072 nt lds
    s_lshl_b32 s22, s4, 5
    s_add_u32 s22, s22, s5
    s_lshl_b32 s23, s22, 11
    s_add_u32 s23, s23, 524288
    s_lshl_b32 s22, s22, 7
    s_add_u32 s22, s22, 32768
    s_sub_u32 s26, s20, 256
    s_cmp_eq_u32 s3, 2
    s_cselect_b32 s26, s26, s22
    s_cselect_b32 s16, 15, 1
    s_cmp_eq_u32 s3, 1
    s_cselect_b32 s26, s23, s26
    s_cselect_b32 s16, 0x1ff, s16
    s_cselect_b32 s23, s23, 33554304
    s_mov_b32 s17, 0
    buffer_store_dwordx4 v[4:7], v2, s[8:11], s23 offen
    s_mov_b64 exec, s[16:17]
    buffer_load_dword v159, v3, s[8:11], s26 offen sc1
    s_mov_b64 exec, -1
    s_barrier
    s_branch L_cw
L_lw:
    s_cmp_eq_u32 s3, 8
    s_cbranch_scc0 L_lw2
    s_cmp_ge_u32 s100, 28
    s_cselect_b32 s12, 0, s5
    s_cmp_ge_u32 s12, 16
    s_cbranch_scc1 L_end
    s_barrier
    s_branch L_w8
L_lw2:
    s_cmp_ge_u32 s100, 28
    s_cbranch_scc1 L_lf
    s_mul_i32 s16, s5, 5
    s_sub_u32 s16, s16, 12
    s_mov_b32 s19, 1
    s_mul_i32 s17, s5, 6
    s_sub_u32 s17, s17, 32
    s_cmp_lt_u32 s5, 20
    s_cselect_b32 s16, s17, s16
    s_cselect_b32 s19, 2, s19
    s_lshl_b32 s17, s5, 2
    s_cmp_lt_u32 s100, 16
    s_cselect_b32 s16, s17, s16
    s_cselect_b32 s19, 0, s19
    s_lshl_b32 s17, s4, 24
    s_lshl_b32 s27, s18, 15
    s_add_u32 s17, s17, s27
    s_add_u32 s17, s17, 15728640
    s_lshl_b32 s27, s18, 11
    s_mov_b32 s30, 134217728
    s_mov_b32 s31, 0x20000
    s_lshr_b32 s21, s16, 4
    s_lshl_b32 s52, s21, 17
    s_xor_b32 s21, s21, s16
    s_and_b32 s21, s21, 3
    s_lshl_b32 s21, s21, 13
    s_add_u32 s52, s52, s21
    s_and_b32 s21, s16, 12
    s_lshl_b32 s21, s21, 9
    s_add_u32 s52, s52, s21
    s_add_u32 s52, s52, s17
    s_add_u32 s16, s16, 1
    s_lshr_b32 s21, s16, 4
    s_lshl_b32 s53, s21, 17
    s_xor_b32 s21, s21, s16
    s_and_b32 s21, s21, 3
    s_lshl_b32 s21, s21, 13
    s_add_u32 s53, s53, s21
    s_and_b32 s21, s16, 12
    s_lshl_b32 s21, s21, 9
    s_add_u32 s53, s53, s21
    s_add_u32 s53, s53, s17
    s_add_u32 s16, s16, 1
    s_lshr_b32 s21, s16, 4
    s_lshl_b32 s54, s21, 17
    s_xor_b32 s21, s21, s16
    s_and_b32 s21, s21, 3
    s_lshl_b32 s21, s21, 13
    s_add_u32 s54, s54, s21
    s_and_b32 s21, s16, 12
    s_lshl_b32 s21, s21, 9
    s_add_u32 s54, s54, s21
    s_add_u32 s54, s54, s17
    s_add_u32 s16, s16, 1
    s_and_b32 s20, s18, 1
    s_lshl_b32 s20, s20, 7
    v_xor_b32 v6, s20, v2
    v_lshlrev_b32 v4, 4, v11
    v_xor_b32 v4, v4, v6
    v_xor_b32 v5, 64, v4
    v_lshlrev_b32 v7, 5, v11
    v_xor_b32 v6, v7, v6
    s_waitcnt lgkmcnt(0)
    s_mov_b32 s28, s34
    s_mov_b32 s29, s35
    s_barrier
    s_add_u32 m0, s27, 16384
    s_nop 0
    buffer_load_dwordx4 v4, s[28:31], s52 offen offset:0 nt lds
    buffer_load_dwordx4 v5, s[28:31], s52 offen offset:1024 nt lds
    s_add_u32 m0, s27, 24576
    s_nop 0
    buffer_load_dwordx4 v4, s[28:31], s53 offen offset:0 nt lds
    buffer_load_dwordx4 v5, s[28:31], s53 offen offset:1024 nt lds
    s_add_u32 m0, s27, 32768
    s_nop 0
    buffer_load_dwordx4 v4, s[28:31], s54 offen offset:0 nt lds
    buffer_load_dwordx4 v5, s[28:31], s54 offen offset:1024 nt lds
    s_lshr_b32 s21, s16, 4
    s_lshl_b32 s55, s21, 17
    s_xor_b32 s21, s21, s16
    s_and_b32 s21, s21, 3
    s_lshl_b32 s21, s21, 13
    s_add_u32 s55, s55, s21
    s_and_b32 s21, s16, 12
    s_lshl_b32 s21, s21, 9
    s_add_u32 s55, s55, s21
    s_add_u32 s55, s55, s17
    s_add_u32 s16, s16, 1
    s_lshr_b32 s21, s16, 4
    s_lshl_b32 s56, s21, 17
    s_xor_b32 s21, s21, s16
    s_and_b32 s21, s21, 3
    s_lshl_b32 s21, s21, 13
    s_add_u32 s56, s56, s21
    s_and_b32 s21, s16, 12
    s_lshl_b32 s21, s21, 9
    s_add_u32 s56, s56, s21
    s_add_u32 s56, s56, s17
    s_add_u32 s16, s16, 1
    s_lshr_b32 s21, s16, 4
    s_lshl_b32 s57, s21, 17
    s_xor_b32 s21, s21, s16
    s_and_b32 s21, s21, 3
    s_lshl_b32 s21, s21, 13
    s_add_u32 s57, s57, s21
    s_and_b32 s21, s16, 12
    s_lshl_b32 s21, s21, 9
    s_add_u32 s57, s57, s21
    s_add_u32 s57, s57, s17
    s_add_u32 s16, s16, 1
    s_load_dwordx2 s[8:9], s[0:1], 96
    s_load_dwordx2 s[40:41], s[0:1], 32
    s_load_dwordx2 s[42:43], s[0:1], 64
    s_load_dwordx2 s[32:33], s[0:1], 48
    v_lshrrev_b32 v112, 2, v10
    v_and_b32 v113, 1, v11
    v_lshl_add_u32 v113, v113, 2, v112
    s_lshl_b32 s12, s18, 1
    v_xor_b32 v113, s12, v113
    v_lshlrev_b32 v113, 5, v113
    v_lshl_add_u32 v112, v11, 3, v112
    v_lshl_add_u32 v112, v112, 8, v113
    v_and_b32 v13, 3, v0
    v_lshl_add_u32 v112, v13, 3, v112
    v_add_u32 v112, 65536, v112
    v_xor_b32 v113, 32, v112
    v_mul_u32_u24 v114, 464, v13
    v_lshl_add_u32 v114, v11, 4, v114
    v_add_u32 v114, 149504, v114
    v_and_b32 v3, 1, v0
    v_lshlrev_b32 v3, 6, v3
    v_lshl_add_u32 v3, v11, 4, v3
    v_and_b32 v12, 2, v0
    v_lshl_add_u32 v3, v12, 8, v3
    s_lshl_b32 s24, s4, 16
    s_lshl_b32 s25, s5, 11
    s_add_u32 s24, s24, s25
    s_lshl_b32 s25, s18, 7
    s_add_u32 s24, s24, s25
    s_add_u32 s25, s24, 2097152
    s_add_u32 s24, s24, 524288
    s_mov_b32 s50, 0x000f000f
    s_mov_b32 s51, 0x000f000f
    s_waitcnt lgkmcnt(0)
    s_load_dword s6, s[8:9], 0
    v_mov_b64 v[40:41], 0
    v_mov_b64 v[42:43], 0
    v_mov_b64 v[44:45], 0
    v_mov_b64 v[46:47], 0
    v_mov_b64 v[48:49], 0
    v_mov_b64 v[50:51], 0
    v_mov_b32 v52, 0x3f803f80
    v_mov_b32 v53, 0x3f803f80
    v_mov_b32 v54, 0x3f803f80
    v_mov_b32 v55, 0x3f803f80
    v_mov_b32 v116, 148608
    v_lshlrev_b32 v115, 4, v13
    v_add_u32 v115, 148480, v115
    s_mul_i32 s12, s18, 0x70
    s_sub_u32 s26, s25, s12
    s_lshl_b32 s22, s18, 2
    s_add_u32 s22, s22, 148608
    v_mov_b32 v1, s22
    s_lshr_b32 s46, s3, 2
    s_lshl_b32 s44, s4, 16
    s_lshl_b32 s45, s46, 15
    s_add_u32 s44, s44, s45
    s_lshr_b32 s45, s5, 3
    s_lshl_b32 s45, s45, 9
    s_add_u32 s44, s44, s45
    s_lshl_b32 s45, s18, 7
    s_add_u32 s44, s44, s45
    s_add_u32 s44, s44, 524288
    s_add_u32 s45, s44, 16384
    v_and_b32 v152, 0x70, v2
    v_lshl_add_u32 v152, v8, 11, v152
    s_lshl_b32 s47, s46, 9
    s_lshl_b32 s48, s18, 6
    s_add_u32 s47, s47, s48
    s_add_u32 s47, s47, 147456
    v_and_b32 v153, 32, v0
    v_and_b32 v154, 3, v0
    v_lshl_add_u32 v153, v154, 3, v153
    v_and_b32 v154, 1, v11
    v_lshl_add_u32 v153, v154, 2, v153
    v_and_b32 v154, 4, v0
    v_lshl_add_u32 v153, v154, 6, v153
    v_add_u32 v153, s47, v153
    s_lshl_b32 s47, s46, 6
    s_add_u32 s47, s47, 148992
    v_lshlrev_b32 v154, 5, v154
    v_lshl_add_u32 v154, v8, 2, v154
    v_add_u32 v154, s47, v154
    s_mov_b32 s48, -1
    s_min_u32 s49, s46, s4
    s_sub_u32 s49, s49, 1
    v_mov_b32 v155, 0xffff0000
    v_mov_b64 v[156:157], 0
    v_mov_b64 v[158:159], 0
    s_sub_u32 s12, s5, 16
    s_mul_i32 s13, s12, 43
    s_lshr_b32 s13, s13, 7
    s_mul_i32 s22, s13, 3
    s_sub_u32 s34, s12, s22
    s_add_u32 s12, s34, 1
    s_lshl_b32 s22, s4, 2
    s_add_u32 s13, s13, s22
    s_sub_u32 s13, s13, 4
    s_bfe_u32 s22, s13, 0x20001
    s_xor_b32 s12, s12, s22
    s_lshl_b32 s12, s12, 13
    s_cmp_lg_u32 s4, 0
    s_cselect_b32 s38, -1, 0
    s_mov_b32 s39, 0
    s_lshl_b32 s23, s13, 7
    s_lshl_b32 s13, s13, 16
    s_add_u32 s12, s12, s13
    s_lshr_b32 s13, s18, 1
    s_lshl_b32 s13, s13, 15
    s_add_u32 s12, s12, s13
    s_and_b32 s13, s18, 1
    s_lshl_b32 s13, s13, 12
    s_add_u32 s12, s12, s13
    v_lshl_add_u32 v117, v0, 7, s12
    v_xor_b32 v119, 0x6000, v117
    s_lshl_b32 s12, s34, 2
    s_add_u32 s12, s12, s18
    s_mul_i32 s12, s12, 114688
    s_add_u32 s12, s12, s23
    s_add_u32 s12, s12, 917504
    v_mul_u32_u24 v120, 3584, v0
    v_add_u32 v120, s12, v120
    s_waitcnt lgkmcnt(0)
    s_mul_i32 s7, s6, 0x9E3779B1
    s_add_u32 s7, s7, 0x7F4A7C15
    s_bitset0_b32 s7, 31
    s_mul_i32 s6, s6, 0x85EBCA6B
    s_add_u32 s6, s6, 0x165667B1
    v_mov_b32 v146, s6
    v_mov_b32 v147, s7
    s_barrier
    s_barrier
    s_add_u32 m0, s27, 40960
    s_waitcnt vmcnt(5)
    buffer_load_dwordx4 v4, s[28:31], s55 offen offset:0 nt lds
    s_waitcnt vmcnt(5)
    buffer_load_dwordx4 v5, s[28:31], s55 offen offset:1024 nt lds
    s_cmp_lt_u32 s5, 16
    s_cbranch_scc0 L_xk
    s_lshl_b32 s22, s4, 1
    s_lshr_b32 s23, s5, 3
    s_add_u32 s22, s22, s23
    s_and_b32 s21, s22, 3
    s_lshl_b32 s23, s18, 2
    s_add_u32 s21, s21, s23
    s_lshl_b32 s22, s22, 18
    s_lshl_b32 s23, s21, 13
    s_add_u32 s22, s22, s23
    s_and_b32 s23, s5, 7
    s_lshl_b32 s23, s23, 7
    s_add_u32 s22, s22, s23
    s_lshl_b32 s23, s21, 10
    s_add_u32 s23, s23, 114688
    s_mov_b32 s12, s40
    s_mov_b32 s13, s41
    s_lshr_b32 s20, s20, 1
    v_lshl_add_u32 v12, v8, 10, v9
    v_xor_b32 v12, s20, v12
    s_xor_b32 m0, s23, 0
    s_xor_b32 s21, s22, 0
    s_waitcnt vmcnt(5)
    buffer_load_dwordx4 v12, s[12:15], s21 offen nt lds
    s_xor_b32 m0, s23, 1024
    s_xor_b32 s21, s22, 8192
    s_waitcnt vmcnt(5)
    buffer_load_dwordx4 v12, s[12:15], s21 offen nt lds
    s_xor_b32 m0, s23, 2048
    s_xor_b32 s21, s22, 16384
    s_waitcnt vmcnt(5)
    buffer_load_dwordx4 v12, s[12:15], s21 offen nt lds
    s_xor_b32 m0, s23, 3072
    s_xor_b32 s21, s22, 24576
    s_waitcnt vmcnt(5)
    buffer_load_dwordx4 v12, s[12:15], s21 offen nt lds
    s_add_u32 s23, s23, 16384
    s_xor_b32 m0, s23, 0
    s_xor_b32 s21, s22, 131072
    s_waitcnt vmcnt(5)
    buffer_load_dwordx4 v12, s[12:15], s21 offen nt lds
    s_xor_b32 m0, s23, 1024
    s_xor_b32 s21, s22, 139264
    s_waitcnt vmcnt(5)
    s_mov_b64 exec, 1
    ds_write_b32 v1, v1
    s_mov_b64 exec, -1
    buffer_load_dwordx4 v12, s[12:15], s21 offen nt lds
    s_xor_b32 m0, s23, 2048
    s_xor_b32 s21, s22, 147456
    s_waitcnt vmcnt(5)
    buffer_load_dwordx4 v12, s[12:15], s21 offen nt lds
    s_xor_b32 m0, s23, 3072
    s_xor_b32 s21, s22, 155648
    s_waitcnt vmcnt(5)
    buffer_load_dwordx4 v12, s[12:15], s21 offen nt lds
L_xw:
    s_mov_b32 s28, s36
    s_mov_b32 s29, s37
    s_branch L_vm
L_xk:
    s_cmp_eq_u32 s19, 0
    s_cbranch_scc1 L_xw
    s_add_u32 m0, s27, 49152
    s_waitcnt vmcnt(5)
    buffer_load_dwordx4 v4, s[28:31], s56 offen offset:0 nt lds
    s_waitcnt vmcnt(5)
    buffer_load_dwordx4 v5, s[28:31], s56 offen offset:1024 nt lds
    s_cmp_eq_u32 s19, 1
    s_cbranch_scc1 L_xv
    s_add_u32 m0, s27, 57344
    s_waitcnt vmcnt(5)
    buffer_load_dwordx4 v4, s[28:31], s57 offen offset:0 nt lds
    s_waitcnt vmcnt(5)
    buffer_load_dwordx4 v5, s[28:31], s57 offen offset:1024 nt lds
    s_mov_b32 s28, s36
    s_mov_b32 s29, s37
    s_add_u32 m0, s27, 106496
    s_waitcnt vmcnt(5)
    buffer_load_dwordx4 v6, s[28:31], s57 offen offset:0 nt lds
    s_waitcnt vmcnt(5)
    buffer_load_dwordx4 v6, s[28:31], s57 offen offset:1024 nt lds
L_xv:
    s_mov_b32 s28, s36
    s_mov_b32 s29, s37
    s_add_u32 m0, s27, 98304
    s_waitcnt vmcnt(5)
    buffer_load_dwordx4 v6, s[28:31], s56 offen offset:0 nt lds
    s_waitcnt vmcnt(5)
    buffer_load_dwordx4 v6, s[28:31], s56 offen offset:1024 nt lds
L_vm:
    s_add_u32 m0, s27, 65536
    s_waitcnt vmcnt(5)
    buffer_load_dwordx4 v6, s[28:31], s52 offen offset:0 nt lds
    s_waitcnt vmcnt(5)
    s_cmp_lg_u32 s19, 2
    s_cbranch_scc1 L_kf_1
    s_mov_b64 exec, 1
    ds_write_b32 v1, v1
    s_mov_b64 exec, -1
L_kf_1:
    buffer_load_dwordx4 v6, s[28:31], s52 offen offset:1024 nt lds
    s_add_u32 m0, s27, 73728
    s_waitcnt vmcnt(5)
    buffer_load_dwordx4 v6, s[28:31], s53 offen offset:0 nt lds
    s_waitcnt vmcnt(5)
    s_cmp_lg_u32 s19, 1
    s_cbranch_scc1 L_kf_2
    s_mov_b64 exec, 1
    ds_write_b32 v1, v1
    s_mov_b64 exec, -1
L_kf_2:
    buffer_load_dwordx4 v6, s[28:31], s53 offen offset:1024 nt lds
    s_add_u32 m0, s27, 81920
    s_waitcnt vmcnt(5)
    buffer_load_dwordx4 v6, s[28:31], s54 offen offset:0 nt lds
    s_waitcnt vmcnt(5)
    s_cmp_lg_u32 s19, 0
    s_cbranch_scc1 L_kf_3
    s_mov_b64 exec, 1
    ds_write_b32 v1, v1
    s_mov_b64 exec, -1
L_kf_3:
    buffer_load_dwordx4 v6, s[28:31], s54 offen offset:1024 nt lds
    s_add_u32 m0, s27, 90112
    s_waitcnt vmcnt(5)
    buffer_load_dwordx4 v6, s[28:31], s55 offen offset:0 nt lds
    s_waitcnt vmcnt(5)
    buffer_load_dwordx4 v6, s[28:31], s55 offen offset:1024 nt lds
    s_waitcnt vmcnt(6)
    s_barrier
    ds_read_b128 v[16:19], v114 offset:0
    ds_read_b128 v[20:23], v114 offset:64
    ds_read_b128 v[24:27], v114 offset:128
    ds_read_b128 v[28:31], v114 offset:192
    ds_read_b128 v[56:59], v115
    ds_read_b128 v[60:63], v116 offset:32
    ds_read_b64_tr_b16 v[64:65], v112 offset:0
    ds_read_b64_tr_b16 v[66:67], v112 offset:1024
    ds_read_b64_tr_b16 v[68:69], v113 offset:0
    ds_read_b64_tr_b16 v[70:71], v113 offset:1024
    s_cmp_eq_u32 s19, 0
    s_cbranch_scc1 L_nox
    ds_read_b128 v[32:35], v114 offset:256
    ds_read_b64_tr_b16 v[96:97], v112 offset:32768
    ds_read_b64_tr_b16 v[98:99], v112 offset:33792
    ds_read_b64_tr_b16 v[100:101], v113 offset:32768
    ds_read_b64_tr_b16 v[102:103], v113 offset:33792
    s_cmp_eq_u32 s19, 1
    s_cbranch_scc1 L_x1
    ds_read_b128 v[36:39], v114 offset:320
    ds_read_b64_tr_b16 v[104:105], v112 offset:40960
    ds_read_b64_tr_b16 v[106:107], v112 offset:41984
    ds_read_b64_tr_b16 v[108:109], v113 offset:40960
    ds_read_b64_tr_b16 v[110:111], v113 offset:41984
    s_waitcnt lgkmcnt(0)
    v_mfma_f32_16x16x32_bf16 v[40:43], v[104:107], v[36:39], v[40:43]
    v_mfma_f32_16x16x32_bf16 v[44:47], v[108:111], v[36:39], v[44:47]
    v_mfma_f32_16x16x32_bf16 v[48:51], v[52:55], v[36:39], v[48:51]
L_x1:
    s_waitcnt lgkmcnt(0)
    v_mfma_f32_16x16x32_bf16 v[40:43], v[96:99], v[32:35], v[40:43]
    v_mfma_f32_16x16x32_bf16 v[44:47], v[100:103], v[32:35], v[44:47]
    v_mfma_f32_16x16x32_bf16 v[48:51], v[52:55], v[32:35], v[48:51]
L_nox:
    s_waitcnt vmcnt(4)
    s_barrier
    ds_read_b64_tr_b16 v[72:73], v112 offset:8192
    ds_read_b64_tr_b16 v[74:75], v112 offset:9216
    ds_read_b64_tr_b16 v[76:77], v113 offset:8192
    ds_read_b64_tr_b16 v[78:79], v113 offset:9216
    s_waitcnt lgkmcnt(4)
    v_mfma_f32_16x16x32_bf16 v[40:43], v[64:67], v[16:19], v[40:43]
    v_mfma_f32_16x16x32_bf16 v[44:47], v[68:71], v[16:19], v[44:47]
    v_mfma_f32_16x16x32_bf16 v[48:51], v[52:55], v[16:19], v[48:51]
    v_mfma_f32_16x16x32_bf16 v[48:51], v[52:55], v[20:23], v[48:51]
    v_mfma_f32_16x16x32_bf16 v[48:51], v[52:55], v[24:27], v[48:51]
    v_mfma_f32_16x16x32_bf16 v[48:51], v[52:55], v[28:31], v[48:51]
    v_or3_b32 v60, v60, v61, v62
    v_or_b32 v60, v60, v63
    s_nop 0
    v_readfirstlane_b32 s59, v60
    s_waitcnt vmcnt(2)
    s_barrier
    ds_read_b64_tr_b16 v[80:81], v112 offset:16384
    ds_read_b64_tr_b16 v[82:83], v112 offset:17408
    ds_read_b64_tr_b16 v[84:85], v113 offset:16384
    ds_read_b64_tr_b16 v[86:87], v113 offset:17408
    s_waitcnt lgkmcnt(4)
    v_mfma_f32_16x16x32_bf16 v[40:43], v[72:75], v[20:23], v[40:43]
    v_mfma_f32_16x16x32_bf16 v[44:47], v[76:79], v[20:23], v[44:47]
    s_cmp_lg_u32 s3, 4
    s_cbranch_scc1 L_noml
    v_max_f32 v56, v56, v57
    v_max3_f32 v144, v56, v58, v59
    v_mov_b32 v145, v48
    s_mov_b64 exec, 15
    s_cmp_eq_u32 s59, 1
    s_cbranch_scc0 L_mlb
    buffer_store_dwordx4 v[144:147], v2, s[8:11], s24 offen offset:1024
L_mlc:
    s_mov_b64 exec, -1
    s_waitcnt vmcnt(1)
    s_branch L_mld
L_mlb:
    buffer_store_dwordx4 v[144:147], v2, s[8:11], s25 offen offset:1024 sc1
    s_branch L_mlc
L_noml:
    s_waitcnt vmcnt(0)
L_mld:
    s_barrier
    ds_read_b64_tr_b16 v[88:89], v112 offset:24576
    ds_read_b64_tr_b16 v[90:91], v112 offset:25600
    ds_read_b64_tr_b16 v[92:93], v113 offset:24576
    ds_read_b64_tr_b16 v[94:95], v113 offset:25600
    s_waitcnt lgkmcnt(4)
    v_mfma_f32_16x16x32_bf16 v[40:43], v[80:83], v[24:27], v[40:43]
    v_mfma_f32_16x16x32_bf16 v[44:47], v[84:87], v[24:27], v[44:47]
    s_waitcnt lgkmcnt(2)
    v_mfma_f32_16x16x32_bf16 v[40:43], v[88:91], v[28:31], v[40:43]
    s_waitcnt lgkmcnt(0)
    v_mfma_f32_16x16x32_bf16 v[44:47], v[92:95], v[28:31], v[44:47]
    s_mov_b64 exec, s[50:51]
    s_cmp_eq_u32 s59, 1
    s_nop 3
    v_cvt_pk_bf16_f32 v12, v40, v41
    v_cvt_pk_bf16_f32 v13, v42, v43
    v_cvt_pk_bf16_f32 v14, v44, v45
    v_cvt_pk_bf16_f32 v15, v46, v47
    s_cbranch_scc0 L_pubb
    buffer_store_dwordx4 v[12:15], v3, s[8:11], s24 offen
    s_mov_b64 exec, -1
    s_cmp_lt_u32 s5, 16
    s_cbranch_scc1 L_ofast
    s_mov_b64 exec, s[38:39]
    s_cbranch_execz L_end
    s_cmp_lg_u32 s34, 2
    s_cbranch_scc1 L_hz1
    global_load_dword v121, v119, s[42:43]
    s_branch L_hz2
L_hz1:
    global_load_dword v121, v120, s[32:33]
L_hz2:
    global_load_dword v118, v117, s[42:43]
    s_endpgm
L_pubb:
    buffer_store_dwordx4 v[12:15], v3, s[8:11], s25 offen sc1
    s_mov_b64 exec, 1
    s_waitcnt vmcnt(0)
    buffer_store_dwordx4 v[144:147], v2, s[8:11], s26 offen offset:1088 sc1
    s_mov_b64 exec, -1
    s_cmp_lt_u32 s5, 16
    s_cbranch_scc1 L_oslow
    s_endpgm
L_w8:
    s_load_dwordx2 s[8:9], s[0:1], 96
    s_waitcnt lgkmcnt(0)
    s_load_dword s6, s[8:9], 0
    s_cmp_lt_u32 s5, 16
    s_cbranch_scc1 L_w8o
    s_lshl_b32 s20, s29, 14
    s_and_b32 s21, s4, 3
    s_lshl_b32 s21, s21, 16
    s_add_u32 s20, s20, s21
    s_add_u32 s20, s20, 1048576
    s_lshl_b32 s101, s4, 2
    s_add_u32 s29, s29, s101
    s_sub_u32 s29, s29, 4
    s_lshl_b32 s21, s29, 11
    s_and_b32 s13, s21, 0xe000
    s_add_u32 s21, s21, s13
    s_add_u32 s21, s21, 1310720
    s_add_u32 s22, s21, 8192
    v_lshlrev_b32 v13, 7, v10
    v_and_b32 v14, 1, v11
    v_lshl_add_u32 v13, v14, 13, v13
    v_lshlrev_b32 v14, 7, v0
    s_waitcnt lgkmcnt(0)
    s_barrier
    s_barrier
    buffer_load_dword v16, v13, s[8:11], s21 offen sc1
    s_mul_i32 s7, s6, 0x9E3779B1
    s_add_u32 s7, s7, 0x7F4A7C15
    s_bitset0_b32 s7, 31
    s_mul_i32 s6, s6, 0x85EBCA6B
    s_add_u32 s6, s6, 0x165667B1
    s_getreg_b32 s6, hwreg(HW_REG_XCC_ID, 0, 4)
    s_lshl_b32 s24, s4, 14
    s_add_u32 s24, s24, 131072
    v_lshlrev_b32 v4, 9, v0
    s_mov_b32 exec_hi, 0
    s_waitcnt vmcnt(0)
    buffer_load_dwordx2 v[6:7], v4, s[8:11], s24 offen offset:8 sc1
    s_mov_b32 s16, -1
    s_mov_b32 s17, -1
    s_mov_b32 s19, 1
L_lat:
    s_memtime s[12:13]
    s_waitcnt lgkmcnt(0)
    s_load_dword s23, s[8:9], s21 glc
    s_waitcnt lgkmcnt(0)
    s_memtime s[14:15]
    s_add_u32 s21, s21, 512
    s_waitcnt lgkmcnt(0)
    s_sub_u32 s12, s14, s12
    s_min_u32 s16, s16, s12
    s_memtime s[12:13]
    s_waitcnt lgkmcnt(0)
    s_load_dword s23, s[8:9], s22 glc
    s_waitcnt lgkmcnt(0)
    s_memtime s[14:15]
    s_add_u32 s22, s22, 512
    s_waitcnt lgkmcnt(0)
    s_sub_u32 s12, s14, s12
    s_min_u32 s17, s17, s12
    s_sub_u32 s19, s19, 1
    s_cbranch_scc0 L_lat
    s_cmp_lt_u32 s17, s16
    s_cselect_b32 s12, 0x2000, 0
    s_mov_b64 exec, -1
    s_add_u32 s20, s20, s12
    buffer_load_dword v16, v14, s[8:11], s20 offen sc1
    s_mov_b32 exec_hi, 0
    s_mov_b32 s13, 3
    s_waitcnt vmcnt(1)
L_lz:
    v_cmp_ne_u64 vcc, s[6:7], v[6:7]
    s_cbranch_vccz L_lzd
    s_sub_u32 s13, s13, 1
    s_cbranch_scc1 L_lzd
    buffer_load_dwordx2 v[6:7], v4, s[8:11], s24 offen offset:8 sc1
    s_waitcnt vmcnt(0)
    s_branch L_lz
L_lzd:
    v_mov_b32 v12, s12
    v_mov_b32 v13, s13
    v_mov_b32 v15, 148608
    s_mov_b64 exec, 1
    ds_write_b64 v15, v[12:13] offset:16
    s_waitcnt lgkmcnt(0)
    s_barrier
    s_endpgm
L_w8o:
    s_waitcnt lgkmcnt(0)
    s_barrier
    s_barrier
    s_mul_i32 s7, s6, 0x9E3779B1
    s_add_u32 s7, s7, 0x7F4A7C15
    s_bitset0_b32 s7, 31
    s_mul_i32 s6, s6, 0x85EBCA6B
    s_add_u32 s6, s6, 0x165667B1
    v_and_b32 v20, 31, v0
    v_lshlrev_b32 v20, 11, v20
    v_lshrrev_b32 v21, 5, v0
    v_lshl_add_u32 v20, v21, 4, v20
    v_lshlrev_b32 v21, 2, v0
    v_add_u32 v21, 148992, v21
    s_lshl_b32 s22, s4, 16
    s_lshr_b32 s23, s5, 3
    s_lshl_b32 s23, s23, 5
    s_add_u32 s22, s22, s23
    s_add_u32 s22, s22, 525312
    s_cmp_eq_u32 s4, 0
    s_cselect_b32 s16, -1, 0x0fffffff
    s_mov_b32 s17, s16
    v_mov_b32 v32, 0xff800000
    v_mov_b32 v33, 0
    v_mov_b32 v1, 148608
    v_mov_b32 v34, s6
    v_mov_b32 v35, s7
    s_barrier
    ds_read_b128 v[24:27], v1 offset:32
    s_waitcnt lgkmcnt(0)
    v_or3_b32 v24, v24, v25, v26
    v_or_b32 v24, v24, v27
    s_nop 0
    v_readfirstlane_b32 s59, v24
    s_cmp_eq_u32 s59, 1
    s_cselect_b32 s23, 0, 1572864
    s_add_u32 s22, s22, s23
    s_setprio 3
    s_barrier
    s_barrier
    s_barrier
    s_mov_b64 exec, s[16:17]
    buffer_load_dwordx4 v[32:35], v20, s[8:11], s22 offen sc1
    s_mov_b64 exec, -1
    s_movk_i32 s58, 20000
    s_branch L_poll_4w
L_poll_4:
    s_mov_b64 exec, vcc
    buffer_load_dwordx4 v[32:35], v20, s[8:11], s22 offen sc1
L_sk_6:
    s_mov_b64 exec, -1
    s_sub_u32 s58, s58, 1
    s_cbranch_scc1 L_done_5t
L_poll_4w:
    s_waitcnt vmcnt(0)
    v_cmp_ne_u64 vcc, s[6:7], v[34:35]
    s_cbranch_vccnz L_poll_4
L_done_5:
    v_max_f32_dpp v27, v32, v32 quad_perm:[1,0,3,2] row_mask:0xf bank_mask:0xf
    s_nop 1
    v_max_f32_dpp v27, v27, v27 quad_perm:[2,3,0,1] row_mask:0xf bank_mask:0xf
    s_nop 1
    v_max_f32_dpp v27, v27, v27 row_half_mirror row_mask:0xf bank_mask:0xf
    s_nop 1
    v_max_f32_dpp v27, v27, v27 row_mirror row_mask:0xf bank_mask:0xf
    v_mov_b32 v26, v27
    s_nop 1
    v_permlane16_swap_b32 v26, v27
    v_max_f32 v27, v27, v26
    v_sub_f32 v32, v32, v27
    v_exp_f32 v28, v32
    s_nop 0
    v_mul_f32 v30, v33, v28
    s_nop 1
    v_add_f32_dpp v30, v30, v30 quad_perm:[1,0,3,2] row_mask:0xf bank_mask:0xf
    s_nop 1
    v_add_f32_dpp v30, v30, v30 quad_perm:[2,3,0,1] row_mask:0xf bank_mask:0xf
    s_nop 1
    v_add_f32_dpp v30, v30, v30 row_half_mirror row_mask:0xf bank_mask:0xf
    s_nop 1
    v_add_f32_dpp v30, v30, v30 row_mirror row_mask:0xf bank_mask:0xf
    v_mov_b32 v26, v30
    s_nop 1
    v_permlane16_swap_b32 v26, v30
    v_add_f32 v30, v30, v26
    v_rcp_f32 v30, v30
    s_nop 0
    v_mul_f32 v28, v28, v30
    ds_write_b32 v21, v28
    s_endpgm
L_cw:
    s_setprio 2
    s_load_dword s6, s[8:9], 0
    s_load_dwordx8 s[40:47], s[0:1], 32
    s_load_dwordx4 s[48:51], s[0:1], 64
    s_load_dwordx2 s[52:53], s[0:1], 80
    v_lshlrev_b32 v1, 2, v0
    v_cmp_gt_u32 vcc, 16, v0
    v_add_u32 v1, 148480, v1
    ds_write_b32 v1, v4 offset:512
    v_cndmask_b32 v3, 0, -1, vcc
    ds_write_b32 v1, v3
    v_and_b32 v14, 8, v0
    v_lshlrev_b32 v15, 3, v14
    v_lshl_add_u32 v14, v14, 9, v15
    v_lshl_add_u32 v14, v11, 9, v14
    v_and_b32 v15, 1, v11
    v_lshl_add_u32 v14, v15, 5, v14
    v_and_b32 v15, 4, v0
    v_lshl_add_u32 v14, v15, 5, v14
    v_and_b32 v15, 3, v0
    v_lshl_add_u32 v14, v15, 3, v14
    v_and_b32 v15, 1, v0
    v_mul_u32_u24 v15, 0xaaaa, v15
    v_add_u32 v150, 0x4444, v15
    s_lshl_b32 s12, s3, 5
    v_xor_b32 v15, s12, v14
    v_mov_b32 v63, 0xffff0000
    v_lshlrev_b32 v144, 3, v0
    v_lshlrev_b32 v145, 7, v0
    v_mov_b64 v[32:33], 0
    v_mov_b64 v[34:35], 0
    v_mov_b64 v[36:37], 0
    v_mov_b64 v[38:39], 0
    s_lshl_b32 s22, s4, 12
    s_lshl_b32 s23, s5, 2
    s_add_u32 s22, s22, s23
    s_add_u32 s22, s22, 32768
    v_mov_b32 v1, 148608
    s_lshl_b32 s12, s3, 2
    v_add_u32 v148, s12, v1
    s_getreg_b32 s15, hwreg(HW_REG_XCC_ID, 0, 4)
    v_add_u32 v3, 147456, v2
    s_cmp_lg_u32 s3, 0
    s_cbranch_scc1 L_nln
    s_waitcnt vmcnt(6)
    v_lshlrev_b32 v20, 16, v16
    v_and_b32 v21, v63, v16
    v_lshlrev_b32 v22, 16, v17
    v_and_b32 v23, v63, v17
    v_lshlrev_b32 v24, 16, v18
    v_and_b32 v25, v63, v18
    v_lshlrev_b32 v26, 16, v19
    v_and_b32 v27, v63, v19
    v_pk_mul_f32 v[30:31], v[20:21], v[20:21]
    v_pk_add_f32 v[28:29], v[20:21], v[22:23]
    v_pk_fma_f32 v[30:31], v[22:23], v[22:23], v[30:31]
    v_pk_fma_f32 v[30:31], v[24:25], v[24:25], v[30:31]
    v_pk_add_f32 v[28:29], v[28:29], v[24:25]
    v_pk_fma_f32 v[30:31], v[26:27], v[26:27], v[30:31]
    v_pk_add_f32 v[28:29], v[28:29], v[26:27]
    v_add_f32 v28, v28, v29
    v_add_f32 v29, v30, v31
    s_nop 1
    v_permlane32_swap_b32 v28, v29
    v_add_f32 v28, v28, v29
    s_nop 1
    v_add_f32_dpp v28, v28, v28 quad_perm:[1,0,3,2] row_mask:0xf bank_mask:0xf
    s_nop 1
    v_add_f32_dpp v28, v28, v28 quad_perm:[2,3,0,1] row_mask:0xf bank_mask:0xf
    s_nop 1
    v_add_f32_dpp v28, v28, v28 row_half_mirror row_mask:0xf bank_mask:0xf
    s_nop 1
    v_add_f32_dpp v28, v28, v28 row_mirror row_mask:0xf bank_mask:0xf
    v_mov_b32 v29, v28
    s_nop 1
    v_permlane16_swap_b32 v29, v28
    v_add_f32 v28, v28, v29
    v_mul_f32 v28, 0x3b000000, v28
    v_mov_b32 v29, v28
    s_nop 1
    v_permlane32_swap_b32 v28, v29
    v_fma_f32 v29, -v28, v28, v29
    v_cvt_pk_bf16_f32 v28, 0, v28
    v_max_f32 v29, 0, v29
    v_cvt_pk_bf16_f32 v29, 0, v29
    v_add_f32 v29, 0x3727c5ac, v29
    v_cvt_pk_bf16_f32 v29, 0, v29
    v_sqrt_f32 v29, v29
    s_nop 0
    v_pk_add_f32 v[20:21], v[20:21], v[28:29] op_sel_hi:[1,0] neg_lo:[0,1] neg_hi:[0,1]
    v_pk_add_f32 v[22:23], v[22:23], v[28:29] op_sel_hi:[1,0] neg_lo:[0,1] neg_hi:[0,1]
    v_cvt_pk_bf16_f32 v29, 0, v29
    v_rcp_f32 v30, v29
    v_pk_add_f32 v[24:25], v[24:25], v[28:29] op_sel_hi:[1,0] neg_lo:[0,1] neg_hi:[0,1]
    v_pk_add_f32 v[26:27], v[26:27], v[28:29] op_sel_hi:[1,0] neg_lo:[0,1] neg_hi:[0,1]
    v_cvt_pk_bf16_f32 v20, 0, v20
    v_cvt_pk_bf16_f32 v21, 0, v21
    v_cvt_pk_bf16_f32 v22, 0, v22
    v_cvt_pk_bf16_f32 v23, 0, v23
    v_cvt_pk_bf16_f32 v24, 0, v24
    v_cvt_pk_bf16_f32 v25, 0, v25
    v_cvt_pk_bf16_f32 v26, 0, v26
    v_cvt_pk_bf16_f32 v27, 0, v27
    v_pk_mul_f32 v[20:21], v[20:21], v[30:31] op_sel_hi:[1,0]
    v_pk_mul_f32 v[22:23], v[22:23], v[30:31] op_sel_hi:[1,0]
    v_pk_mul_f32 v[24:25], v[24:25], v[30:31] op_sel_hi:[1,0]
    v_pk_mul_f32 v[26:27], v[26:27], v[30:31] op_sel_hi:[1,0]
    v_cvt_pk_bf16_f32 v16, v20, v21
    v_cvt_pk_bf16_f32 v17, v22, v23
    v_cvt_pk_bf16_f32 v18, v24, v25
    v_cvt_pk_bf16_f32 v19, v26, v27
    ds_write_b128 v3, v[16:19]
L_nln:
    s_waitcnt lgkmcnt(0)
    s_mul_i32 s7, s6, 0x9E3779B1
    s_add_u32 s7, s7, 0x7F4A7C15
    s_bitset0_b32 s7, 31
    s_mul_i32 s6, s6, 0x85EBCA6B
    s_add_u32 s6, s6, 0x165667B1
    v_mov_b32 v58, s15
    v_mov_b32 v59, s7
    s_waitcnt vmcnt(2)
    s_barrier
    ds_read_b128 v[16:19], v3
    ds_read_b64_tr_b16 v[112:113], v15 offset:0
    ds_read_b64_tr_b16 v[114:115], v15 offset:256
    ds_read_b64_tr_b16 v[116:117], v15 offset:2048
    ds_read_b64_tr_b16 v[118:119], v15 offset:2304
    ds_read_b64_tr_b16 v[120:121], v15 offset:8192
    ds_read_b64_tr_b16 v[122:123], v15 offset:8448
    ds_read_b64_tr_b16 v[124:125], v15 offset:10240
    ds_read_b64_tr_b16 v[126:127], v15 offset:10496
    s_waitcnt lgkmcnt(4)
    v_smfmac_f32_16x16x64_bf16 v[32:35], v[16:19], v[112:119], v150
    s_waitcnt lgkmcnt(0)
    v_smfmac_f32_16x16x64_bf16 v[36:39], v[16:19], v[120:127], v150
    s_nop 7
    v_pk_add_f32 v[56:57], v[32:33], v[38:39]
    v_add_f32 v56, v56, v57
    s_nop 1
    v_mov_b32_dpp v57, v56 quad_perm:[1,1,3,3] row_mask:0xf bank_mask:0xf
    s_waitcnt vmcnt(0)
    s_mov_b64 exec, 0x5555
    buffer_store_dwordx4 v[56:59], v144, s[8:11], s20 offen
    s_cmp_lg_u32 s3, 1
    s_cbranch_scc1 L_nohint
    s_mov_b32 exec_lo, -1
    buffer_store_dword v59, v145, s[8:11], s22 offen
L_nohint:
    s_mov_b64 exec, -1
    s_barrier
    s_cmp_ge_u32 s100, 28
    s_cbranch_scc1 L_cf
    s_cmp_lg_u32 s4, 0
    s_cbranch_scc1 L_nopf0
    s_sub_u32 s13, s5, 16
    s_cbranch_scc1 L_nopf0
    s_lshr_b32 s12, s13, 3
    s_lshl_b32 s12, s12, 18
    s_and_b32 s13, s13, 7
    s_lshl_b32 s13, s13, 12
    s_add_u32 s12, s12, s13
    s_lshl_b32 s13, s3, 15
    s_add_u32 s12, s12, s13
    v_lshlrev_b32 v4, 7, v0
    v_add_u32 v4, 0x20000, v4
    s_mov_b32 exec_lo, 0
    v_lshlrev_b32 v4, 10, v10
    v_add_u32 v4, 0x180, v4
    s_mov_b32 exec_lo, -1
    s_mov_b32 exec_hi, 15
    v_add_u32 v4, s12, v4
    global_load_dword v151, v4, s[40:41]
    s_mov_b64 exec, -1
L_nopf0:
    s_sub_u32 s13, s100, 20
    s_cbranch_scc1 L_nopfo
    s_lshl_b32 s12, s4, 19
    s_lshr_b32 s14, s13, 1
    s_lshl_b32 s14, s14, 17
    s_add_u32 s12, s12, s14
    s_and_b32 s13, s13, 1
    s_lshl_b32 s13, s13, 14
    s_add_u32 s12, s12, s13
    s_lshl_b32 s13, s3, 12
    s_add_u32 s12, s12, s13
    s_add_u32 s12, s12, 0x180
    v_and_b32 v4, 3, v0
    v_lshl_add_u32 v4, v4, 15, s12
    v_and_b32 v5, 12, v0
    v_lshl_add_u32 v4, v5, 8, v4
    global_load_dword v151, v4, s[40:41]
L_nopfo:
    s_mov_b32 s19, 2
    s_cmp_lt_u32 s5, 20
    s_cselect_b32 s19, 4, s19
    s_cmp_lt_u32 s100, 16
    s_cselect_b32 s19, 0, s19
    s_cmp_lt_u32 s3, s19
    s_cselect_b32 s19, 1, 0
    s_mov_b32 s16, 0x00ff00ff
    s_cselect_b32 s16, 0x0fff0fff, s16
    s_mov_b32 s17, s16
    s_lshl_b32 s12, s3, 12
    s_add_u32 s12, s12, 16384
    v_xor_b32 v4, v10, v11
    v_lshlrev_b32 v4, 4, v4
    v_lshl_add_u32 v4, v10, 8, v4
    v_add_u32 v4, s12, v4
    v_xor_b32 v5, 64, v4
    v_xor_b32 v6, 0x80, v4
    v_xor_b32 v7, 0xc0, v4
    v_and_b32 v13, 3, v0
    v_mul_u32_u24 v3, 320, v13
    v_lshl_add_u32 v3, v11, 4, v3
    v_add_u32 v3, 151552, v3
    v_mul_u32_u24 v60, 464, v13
    v_and_b32 v61, 12, v0
    v_lshl_add_u32 v60, v61, 5, v60
    v_lshl_add_u32 v60, v11, 3, v60
    s_lshl_b32 s12, s3, 5
    s_add_u32 s12, s12, 149504
    v_add_u32 v60, s12, v60
    v_lshlrev_b32 v61, 4, v13
    v_add_u32 v61, 148480, v61
    s_lshl_b32 s12, s3, 2
    v_add_u32 v62, s12, v61
    v_mov_b32 v146, 1035273459
    v_mov_b32 v147, 1069066811
    v_add_u32 v15, 114688, v15
    s_lshl_b32 s24, s4, 14
    s_lshl_b32 s25, s3, 10
    s_add_u32 s24, s24, s25
    s_add_u32 s24, s24, 131072
    s_add_u32 s25, s24, 4096
    s_add_u32 s26, s24, 8192
    s_add_u32 s27, s24, 12288
    s_lshl_b32 s12, s4, 12
    s_add_u32 s12, s12, 32768
    s_add_u32 s12, s12, s8
    s_addc_u32 s13, s9, 0
    s_mov_b32 s22, s7
    s_mov_b32 s23, s7
    s_mul_i32 s14, s3, 320
    s_add_u32 s14, s14, 151552
    v_lshl_add_u32 v149, v0, 2, s14
    s_mov_b32 s58, 0
L_hint:
    s_add_u32 s59, s58, 64
    s_load_dwordx16 s[80:95], s[12:13], s58
    s_load_dwordx16 s[32:47], s[12:13], s59
    s_add_u32 s58, s58, 128
    s_cmp_ge_u32 s58, 4096
    s_cbranch_scc1 L_hintd
    s_waitcnt lgkmcnt(0)
    s_cmp_lg_u64 s[80:81], s[22:23]
    s_cbranch_scc1 L_hint
    s_cmp_lg_u64 s[82:83], s[22:23]
    s_cbranch_scc1 L_hint
    s_cmp_lg_u64 s[84:85], s[22:23]
    s_cbranch_scc1 L_hint
    s_cmp_lg_u64 s[86:87], s[22:23]
    s_cbranch_scc1 L_hint
    s_cmp_lg_u64 s[88:89], s[22:23]
    s_cbranch_scc1 L_hint
    s_cmp_lg_u64 s[90:91], s[22:23]
    s_cbranch_scc1 L_hint
    s_cmp_lg_u64 s[92:93], s[22:23]
    s_cbranch_scc1 L_hint
    s_cmp_lg_u64 s[94:95], s[22:23]
    s_cbranch_scc1 L_hint
    s_cmp_lg_u64 s[32:33], s[22:23]
    s_cbranch_scc1 L_hint
    s_cmp_lg_u64 s[34:35], s[22:23]
    s_cbranch_scc1 L_hint
    s_cmp_lg_u64 s[36:37], s[22:23]
    s_cbranch_scc1 L_hint
    s_cmp_lg_u64 s[38:39], s[22:23]
    s_cbranch_scc1 L_hint
    s_cmp_lg_u64 s[40:41], s[22:23]
    s_cbranch_scc1 L_hint
    s_cmp_lg_u64 s[42:43], s[22:23]
    s_cbranch_scc1 L_hint
    s_cmp_lg_u64 s[44:45], s[22:23]
    s_cbranch_scc1 L_hint
    s_cmp_lg_u64 s[46:47], s[22:23]
    s_cbranch_scc1 L_hint
L_hintd:
    s_waitcnt lgkmcnt(0)
    buffer_load_dwordx4 v[32:35], v2, s[8:11], s24 offen sc1
    buffer_load_dwordx4 v[36:39], v2, s[8:11], s25 offen sc1
    buffer_load_dwordx4 v[40:43], v2, s[8:11], s26 offen sc1
    buffer_load_dwordx4 v[44:47], v2, s[8:11], s27 offen sc1
    s_movk_i32 s58, 20000
    s_lshr_b32 s46, s3, 2
    s_lshl_b32 s44, s4, 16
    s_lshl_b32 s45, s46, 15
    s_add_u32 s44, s44, s45
    s_lshr_b32 s45, s5, 3
    s_lshl_b32 s45, s45, 9
    s_add_u32 s44, s44, s45
    s_lshl_b32 s45, s18, 7
    s_add_u32 s44, s44, s45
    s_add_u32 s44, s44, 524288
    s_add_u32 s45, s44, 16384
    v_and_b32 v152, 0x70, v2
    v_lshl_add_u32 v152, v8, 11, v152
    s_lshl_b32 s47, s46, 9
    s_lshl_b32 s48, s18, 6
    s_add_u32 s47, s47, s48
    s_add_u32 s47, s47, 147456
    v_and_b32 v153, 32, v0
    v_and_b32 v154, 3, v0
    v_lshl_add_u32 v153, v154, 3, v153
    v_and_b32 v154, 1, v11
    v_lshl_add_u32 v153, v154, 2, v153
    v_and_b32 v154, 4, v0
    v_lshl_add_u32 v153, v154, 6, v153
    v_add_u32 v153, s47, v153
    s_lshl_b32 s47, s46, 6
    s_add_u32 s47, s47, 148992
    v_lshlrev_b32 v154, 5, v154
    v_lshl_add_u32 v154, v8, 2, v154
    v_add_u32 v154, s47, v154
    s_mov_b32 s48, -1
    s_min_u32 s49, s46, s4
    s_sub_u32 s49, s49, 1
    v_mov_b32 v155, 0xffff0000
    v_mov_b64 v[156:157], 0
    v_mov_b64 v[158:159], 0
L_spin_9:
    ds_read_b128 v[24:27], v1 offset:0
    s_waitcnt lgkmcnt(0)
    v_min_u32 v28, v24, v25
    v_min3_u32 v28, v28, v26, v27
    v_cmp_eq_u32 vcc, 0, v28
    s_cbranch_vccnz L_spin_9
    ds_read_b128 v[64:67], v4 offset:0
    ds_read_b128 v[68:71], v5 offset:0
    ds_read_b128 v[72:75], v6 offset:0
    ds_read_b128 v[76:79], v7 offset:0
    ds_read_b128 v[80:83], v4 offset:16384
    ds_read_b128 v[84:87], v5 offset:16384
    ds_read_b128 v[88:91], v6 offset:16384
    ds_read_b128 v[92:95], v7 offset:16384
    ds_read_b128 v[96:99], v4 offset:32768
    ds_read_b128 v[100:103], v5 offset:32768
    ds_read_b128 v[104:107], v6 offset:32768
    ds_read_b128 v[108:111], v7 offset:32768
    s_branch L_poll_7w
L_poll_7:
    s_cmp_gt_u32 s58, 19997
    s_cbranch_scc1 L_qa
    s_mov_b64 exec, 0x5555
    buffer_store_dwordx4 v[56:59], v144, s[8:11], s21 offen sc1
    s_mov_b64 exec, -1
    s_xor_b32 s24, s24, 393216
    s_xor_b32 s25, s25, 393216
    s_xor_b32 s26, s26, 393216
    s_xor_b32 s27, s27, 393216
L_qa:
    s_mov_b64 exec, s[80:81]
    s_cbranch_execz L_sk_10
    buffer_load_dwordx4 v[32:35], v2, s[8:11], s24 offen sc1
L_sk_10:
    s_mov_b64 exec, s[82:83]
    s_cbranch_execz L_sk_11
    buffer_load_dwordx4 v[36:39], v2, s[8:11], s25 offen sc1
L_sk_11:
    s_mov_b64 exec, s[84:85]
    s_cbranch_execz L_sk_12
    buffer_load_dwordx4 v[40:43], v2, s[8:11], s26 offen sc1
L_sk_12:
    s_mov_b64 exec, s[86:87]
    s_cbranch_execz L_sk_13
    buffer_load_dwordx4 v[44:47], v2, s[8:11], s27 offen sc1
L_sk_13:
    s_mov_b64 exec, -1
    s_sub_u32 s58, s58, 1
    s_cbranch_scc1 L_done_8t
L_poll_7w:
    s_waitcnt vmcnt(0)
    v_cmp_ne_u32 s[80:81], s7, v35
    v_cmp_ne_u32 s[82:83], s7, v39
    v_cmp_ne_u32 s[84:85], s7, v43
    v_cmp_ne_u32 s[86:87], s7, v47
    s_or_b64 s[56:57], s[80:81], s[82:83]
    s_or_b64 s[56:57], s[56:57], s[84:85]
    s_or_b64 s[56:57], s[56:57], s[86:87]
    s_cbranch_scc1 L_poll_7
L_done_8:
    v_pk_add_f32 v[32:33], v[32:33], v[36:37]
    v_pk_add_f32 v[40:41], v[40:41], v[44:45]
    v_pk_add_f32 v[32:33], v[32:33], v[40:41]
    v_cvt_pk_bf16_f32 v32, v32, v33
    ds_write_b32 v149, v32
    s_mov_b64 exec, 1
    ds_write_b32 v148, v148 offset:48
    s_mov_b64 exec, -1
L_qs:
    ds_read_b128 v[48:51], v1 offset:48
    ds_read_b128 v[16:19], v3 offset:0
    ds_read_b128 v[20:23], v3 offset:64
    ds_read_b128 v[24:27], v3 offset:128
    ds_read_b128 v[28:31], v3 offset:192
    v_min3_u32 v53, v34, v38, v42
    v_max3_u32 v52, v34, v38, v42
    v_min3_u32 v53, v53, v46, v58
    v_max3_u32 v52, v52, v46, v58
    s_waitcnt lgkmcnt(4)
    v_min_u32 v48, v48, v49
    v_min3_u32 v48, v48, v50, v51
    v_cmp_eq_u32 vcc, 0, v48
    s_cbranch_vccnz L_qs
    s_waitcnt lgkmcnt(3)
    v_mfma_f32_16x16x32_bf16 v[32:35], v[64:67], v[16:19], 0
    s_waitcnt lgkmcnt(2)
    v_mfma_f32_16x16x32_bf16 v[32:35], v[68:71], v[20:23], v[32:35]
    s_waitcnt lgkmcnt(1)
    v_mfma_f32_16x16x32_bf16 v[32:35], v[72:75], v[24:27], v[32:35]
    s_waitcnt lgkmcnt(0)
    v_mfma_f32_16x16x32_bf16 v[32:35], v[76:79], v[28:31], v[32:35]
    v_cmp_ne_u32 vcc, v52, v53
    v_mfma_f32_16x16x32_bf16 v[36:39], v[80:83], v[16:19], 0
    v_mfma_f32_16x16x32_bf16 v[36:39], v[84:87], v[20:23], v[36:39]
    v_mfma_f32_16x16x32_bf16 v[36:39], v[88:91], v[24:27], v[36:39]
    v_mfma_f32_16x16x32_bf16 v[36:39], v[92:95], v[28:31], v[36:39]
    s_cmp_lg_u64 vcc, 0
    s_cselect_b32 s14, 2, 1
    v_mov_b32 v52, s14
    s_cmp_eq_u32 s19, 0
    s_cbranch_scc1 L_no3
    v_mfma_f32_16x16x32_bf16 v[40:43], v[96:99], v[16:19], 0
    v_mfma_f32_16x16x32_bf16 v[40:43], v[100:103], v[20:23], v[40:43]
    v_mfma_f32_16x16x32_bf16 v[40:43], v[104:107], v[24:27], v[40:43]
    v_mfma_f32_16x16x32_bf16 v[40:43], v[108:111], v[28:31], v[40:43]
    s_nop 7
    v_mov_b32_dpp v32, v40 quad_perm:[0,1,2,3] row_mask:0xf bank_mask:0x4
    v_mov_b32_dpp v33, v41 quad_perm:[0,1,2,3] row_mask:0xf bank_mask:0x4
    v_mov_b32_dpp v34, v42 quad_perm:[0,1,2,3] row_mask:0xf bank_mask:0x4
    v_mov_b32_dpp v35, v43 quad_perm:[0,1,2,3] row_mask:0xf bank_mask:0x4
L_no3:
    s_nop 2
    v_mov_b32_dpp v32, v36 quad_perm:[0,1,2,3] row_mask:0xf bank_mask:0x2
    v_mov_b32_dpp v33, v37 quad_perm:[0,1,2,3] row_mask:0xf bank_mask:0x2
    v_mov_b32_dpp v34, v38 quad_perm:[0,1,2,3] row_mask:0xf bank_mask:0x2
    v_mov_b32_dpp v35, v39 quad_perm:[0,1,2,3] row_mask:0xf bank_mask:0x2
    v_cvt_pk_bf16_f32 v32, 0, v32
    v_cvt_pk_bf16_f32 v33, 0, v33
    v_cvt_pk_bf16_f32 v34, 0, v34
    v_cvt_pk_bf16_f32 v35, 0, v35
    v_pk_mul_f32 v[32:33], v[32:33], v[146:147] op_sel_hi:[1,0]
    v_pk_mul_f32 v[34:35], v[34:35], v[146:147] op_sel_hi:[1,0]
    v_cvt_pk_bf16_f32 v32, 0, v32
    v_cvt_pk_bf16_f32 v33, 0, v33
    v_cvt_pk_bf16_f32 v34, 0, v34
    v_cvt_pk_bf16_f32 v35, 0, v35
    v_pk_mul_f32 v[32:33], v[32:33], v[146:147] op_sel:[0,1]
    v_pk_mul_f32 v[34:35], v[34:35], v[146:147] op_sel:[0,1]
    v_max_f32 v20, v32, v33
    v_max3_f32 v20, v20, v34, v35
    s_nop 1
    v_max_f32_dpp v20, v20, v20 row_ror:4 row_mask:0xf bank_mask:0xf
    s_nop 1
    v_max_f32_dpp v20, v20, v20 row_ror:8 row_mask:0xf bank_mask:0xf
    s_nop 1
    v_permlane32_swap_b32 v20, v21
    v_max_f32 v20, v20, v21
    s_nop 1
    v_permlane16_swap_b32 v20, v21
    v_max_f32 v20, v20, v21
    s_mov_b64 exec, 15
    ds_write_b32 v62, v20
    s_mov_b64 exec, 1
    ds_write_b32 v148, v52 offset:32
    s_mov_b64 exec, -1
    s_movk_i32 s58, 20000
L_spin_14:
    ds_read_b128 v[16:19], v61
    s_sub_u32 s58, s58, 1
    s_waitcnt lgkmcnt(0)
    s_cbranch_scc1 L_spin_14d
    v_max_u32 v21, v16, v17
    v_max_f32 v20, v16, v17
    v_max3_u32 v21, v21, v18, v19
    v_max3_f32 v20, v20, v18, v19
    v_cmp_eq_u32 vcc, -1, v21
    s_cbranch_vccnz L_spin_14
L_spin_14d:
    v_pk_add_f32 v[32:33], v[32:33], v[20:21] op_sel_hi:[1,0] neg_lo:[0,1] neg_hi:[0,1]
    v_pk_add_f32 v[34:35], v[34:35], v[20:21] op_sel_hi:[1,0] neg_lo:[0,1] neg_hi:[0,1]
    v_exp_f32 v32, v32
    v_exp_f32 v33, v33
    v_exp_f32 v34, v34
    v_exp_f32 v35, v35
    v_cvt_pk_bf16_f32 v16, v32, v33
    v_cvt_pk_bf16_f32 v17, v34, v35
    s_mov_b64 exec, s[16:17]
    ds_write_b64 v60, v[16:17]
    s_mov_b64 exec, -1
    s_waitcnt lgkmcnt(0)
    s_barrier
    s_setprio 0
    ds_read_b128 v[24:27], v1 offset:32
    s_waitcnt lgkmcnt(0)
    v_or3_b32 v24, v24, v25, v26
    v_or_b32 v24, v24, v27
    s_nop 0
    v_readfirstlane_b32 s59, v24
    s_cmp_eq_u32 s59, 1
    s_cbranch_scc1 L_qb
    s_mov_b64 exec, 0x5555
    buffer_store_dwordx4 v[56:59], v144, s[8:11], s21 offen sc1
    s_mov_b64 exec, -1
L_qb:
    s_cmp_ge_u32 s5, 16
    s_cbranch_scc1 L_end
    s_barrier
    v_mov_b64 v[64:65], 0
    v_mov_b64 v[66:67], 0
    v_and_b32 v12, 1, v0
    v_lshlrev_b32 v12, 6, v12
    v_lshl_add_u32 v12, v11, 4, v12
    v_and_b32 v13, 2, v0
    v_lshl_add_u32 v12, v13, 8, v12
    v_add_u32 v12, 147456, v12
    s_lshl_b32 s31, s4, 12
    s_and_b32 s13, s31, 0x6000
    s_add_u32 s31, s31, s13
    s_lshl_b32 s13, s5, 8
    s_add_u32 s31, s31, s13
    s_lshl_b32 s13, s3, 16
    s_add_u32 s31, s31, s13
    s_add_u32 s31, s31, 1048576
    s_barrier
    v_lshlrev_b32 v3, 4, v10
    v_lshl_add_u32 v3, v11, 13, v3
    s_lshl_b32 s12, s3, 5
    s_add_u32 s12, s12, 148736
    v_lshl_add_u32 v13, v10, 1, s12
    v_lshlrev_b32 v1, 3, v10
    v_add_u32 v1, 148736, v1
    v_mov_b32 v82, s6
    v_mov_b32 v83, s7
    s_cmp_eq_u32 s59, 1
    s_barrier
    s_cbranch_scc0 L_oslow
L_ofast:
    buffer_load_dwordx4 v[160:163], v152, s[8:11], s44 offen sc1
    s_mov_b64 exec, s[48:49]
    buffer_load_dwordx4 v[156:159], v152, s[8:11], s45 offen sc1
    s_mov_b64 exec, -1
    s_movk_i32 s58, 20000
    s_cmp_ge_u32 s3, 4
    s_cbranch_scc1 L_nwo
    ds_read_b64_tr_b16 v[112:113], v15 offset:0
    ds_read_b64_tr_b16 v[114:115], v15 offset:256
    ds_read_b64_tr_b16 v[116:117], v15 offset:2048
    ds_read_b64_tr_b16 v[118:119], v15 offset:2304
    ds_read_b64_tr_b16 v[120:121], v15 offset:8192
    ds_read_b64_tr_b16 v[122:123], v15 offset:8448
    ds_read_b64_tr_b16 v[124:125], v15 offset:10240
    ds_read_b64_tr_b16 v[126:127], v15 offset:10496
    ds_read_b64_tr_b16 v[128:129], v15 offset:16384
    ds_read_b64_tr_b16 v[130:131], v15 offset:16640
    ds_read_b64_tr_b16 v[132:133], v15 offset:18432
    ds_read_b64_tr_b16 v[134:135], v15 offset:18688
    ds_read_b64_tr_b16 v[136:137], v15 offset:24576
    ds_read_b64_tr_b16 v[138:139], v15 offset:24832
    ds_read_b64_tr_b16 v[140:141], v15 offset:26624
    ds_read_b64_tr_b16 v[142:143], v15 offset:26880
L_nwo:
    s_branch L_poll_15w
L_poll_15:
    s_mov_b64 exec, s[80:81]
    s_cbranch_execz L_sk_17
    buffer_load_dwordx4 v[160:163], v152, s[8:11], s44 offen sc1
L_sk_17:
    s_mov_b64 exec, s[82:83]
    s_cbranch_execz L_sk_18
    buffer_load_dwordx4 v[156:159], v152, s[8:11], s45 offen sc1
L_sk_18:
    s_mov_b64 exec, -1
    s_sub_u32 s58, s58, 1
    s_cbranch_scc1 L_done_16t
L_poll_15w:
    s_waitcnt vmcnt(0)
    v_cmp_eq_u32 s[80:81], -1, v163
    v_cmp_eq_u32 s[82:83], -1, v159
    s_or_b64 s[56:57], s[80:81], s[82:83]
    s_cbranch_scc1 L_poll_15
L_done_16:
    ds_read2_b32 v[28:29], v154 offset0:0 offset1:8
    v_lshlrev_b32 v32, 16, v160
    v_and_b32 v33, v155, v160
    v_lshlrev_b32 v34, 16, v161
    v_and_b32 v35, v155, v161
    v_lshlrev_b32 v36, 16, v162
    v_and_b32 v37, v155, v162
    v_lshlrev_b32 v38, 16, v163
    v_and_b32 v39, v155, v163
    v_lshlrev_b32 v48, 16, v156
    v_and_b32 v49, v155, v156
    v_lshlrev_b32 v50, 16, v157
    v_and_b32 v51, v155, v157
    v_lshlrev_b32 v52, 16, v158
    v_and_b32 v53, v155, v158
    v_lshlrev_b32 v54, 16, v159
    v_and_b32 v55, v155, v159
    s_waitcnt lgkmcnt(0)
    v_max_u32 v30, v28, v29
    v_cmp_eq_u32 vcc, -1, v30
    s_cbranch_vccnz L_spin_19
L_spin_19d:
    v_mul_f32 v32, v28, v32
    v_mul_f32 v33, v28, v33
    v_mul_f32 v34, v28, v34
    v_mul_f32 v35, v28, v35
    v_mul_f32 v36, v28, v36
    v_mul_f32 v37, v28, v37
    v_mul_f32 v38, v28, v38
    v_mul_f32 v39, v28, v39
    v_fmac_f32 v32, v29, v48
    v_fmac_f32 v36, v29, v52
    v_fmac_f32 v33, v29, v49
    v_fmac_f32 v37, v29, v53
    v_fmac_f32 v34, v29, v50
    v_fmac_f32 v38, v29, v54
    v_fmac_f32 v35, v29, v51
    v_fmac_f32 v39, v29, v55
    v_permlane32_swap_b32 v32, v36
    v_permlane32_swap_b32 v33, v37
    v_permlane32_swap_b32 v34, v38
    v_permlane32_swap_b32 v35, v39
    v_add_f32 v32, v32, v36
    v_add_f32 v34, v34, v38
    v_add_f32 v33, v33, v37
    v_add_f32 v35, v35, v39
    v_permlane16_swap_b32 v32, v34
    s_nop 0
    v_permlane16_swap_b32 v33, v35
    v_add_f32 v32, v32, v34
    v_add_f32 v33, v33, v35
    s_nop 0
    v_add_f32_dpp v32, v32, v32 row_ror:8 row_mask:0xf bank_mask:0xf
    v_add_f32_dpp v33, v33, v33 row_ror:8 row_mask:0xf bank_mask:0xf
    v_cvt_pk_bf16_f32 v32, v32, v33
    ds_write_b32 v153, v32
    s_cmp_ge_u32 s3, 4
    s_waitcnt lgkmcnt(0)
    s_barrier
    s_cbranch_scc1 L_end
    ds_read_b128 v[16:19], v12 offset:0
    ds_read_b128 v[20:23], v12 offset:128
    ds_read_b128 v[24:27], v12 offset:256
    ds_read_b128 v[28:31], v12 offset:384
    s_waitcnt lgkmcnt(3)
    v_smfmac_f32_16x16x64_bf16 v[64:67], v[16:19], v[112:119], v150
    s_waitcnt lgkmcnt(2)
    v_smfmac_f32_16x16x64_bf16 v[64:67], v[20:23], v[120:127], v150
    s_waitcnt lgkmcnt(1)
    v_smfmac_f32_16x16x64_bf16 v[64:67], v[24:27], v[128:135], v150
    s_waitcnt lgkmcnt(0)
    v_smfmac_f32_16x16x64_bf16 v[64:67], v[28:31], v[136:143], v150
    s_mov_b64 exec, 0xffff
    s_nop 6
    v_add_f32 v20, v64, v65
    v_add_f32 v21, v66, v67
    v_add_f32 v20, v20, v21
    v_cvt_pk_bf16_f32 v20, v20, v20
    ds_write_b16 v13, v20
    s_mov_b32 exec_lo, -1
    s_waitcnt lgkmcnt(0)
    s_barrier
    ds_read_b64 v[80:81], v1
    s_waitcnt lgkmcnt(0)
    buffer_store_dwordx4 v[80:83], v3, s[8:11], s31 offen sc1
    s_endpgm
L_done_5t:
    s_waitcnt vmcnt(0)
    s_branch L_done_5
L_done_8t:
    s_waitcnt vmcnt(0)
    s_branch L_done_8
L_done_16t:
    s_waitcnt vmcnt(0)
    s_branch L_done_16
L_spin_19:
    s_movk_i32 s58, 20000
L_spin_19l:
    ds_read2_b32 v[28:29], v154 offset0:0 offset1:8
    s_sub_u32 s58, s58, 1
    s_waitcnt lgkmcnt(0)
    s_cbranch_scc1 L_spin_19d
    v_max_u32 v30, v28, v29
    v_cmp_eq_u32 vcc, -1, v30
    s_cbranch_vccnz L_spin_19l
    s_branch L_spin_19d
L_oslow:
    s_add_u32 s44, s44, 1572864
    s_add_u32 s45, s45, 1572864
    s_lshl_b32 s12, s4, 16
    s_lshl_b32 s13, s46, 15
    s_add_u32 s12, s12, s13
    s_lshl_b32 s13, s18, 4
    s_add_u32 s12, s12, s13
    s_add_u32 s12, s12, 2098240
    s_add_u32 s13, s12, 16384
    v_lshlrev_b32 v22, 11, v8
    v_mov_b32 v54, s6
    v_mov_b32 v55, s7
    buffer_load_dwordx4 v[48:51], v22, s[8:11], s12 offen sc1
    s_mov_b64 exec, s[48:49]
    buffer_load_dwordx4 v[52:55], v22, s[8:11], s13 offen sc1
    s_mov_b64 exec, -1
    s_movk_i32 s58, 20000
    s_branch L_poll_20w
L_poll_20:
    s_mov_b64 exec, s[80:81]
    s_cbranch_execz L_sk_22
    buffer_load_dwordx4 v[48:51], v22, s[8:11], s12 offen sc1
L_sk_22:
    s_mov_b64 exec, s[82:83]
    s_cbranch_execz L_sk_23
    buffer_load_dwordx4 v[52:55], v22, s[8:11], s13 offen sc1
L_sk_23:
    s_mov_b64 exec, -1
    s_sub_u32 s58, s58, 1
    s_cbranch_scc1 L_done_21t
L_poll_20w:
    s_waitcnt vmcnt(0)
    v_cmp_ne_u64 s[80:81], s[6:7], v[50:51]
    v_cmp_ne_u64 s[82:83], s[6:7], v[54:55]
    s_or_b64 s[56:57], s[80:81], s[82:83]
    s_cbranch_scc1 L_poll_20
L_done_21:
    s_branch L_ofast
L_lf:
    s_lshl_b32 s101, s4, 2
    s_add_u32 s29, s29, s101
    s_sub_u32 s29, s29, 4
    s_barrier
    s_load_dwordx2 s[12:13], s[0:1], 48
    s_load_dwordx2 s[48:49], s[0:1], 64
    s_load_dwordx2 s[8:9], s[0:1], 96
    s_load_dwordx2 s[52:53], s[0:1], 80
    s_mov_b32 s14, 1835008
    v_mul_u32_u24 v4, 3584, v8
    v_add_u32 v4, v4, v9
    v_xor_b32 v5, 64, v4
    s_mul_i32 s26, s18, 28672
    s_lshl_b32 s27, s29, 7
    s_add_u32 s26, s26, s27
    s_lshl_b32 s20, s18, 10
    s_add_u32 m0, s20, 16384
    s_lshl_b32 s20, s18, 14
    v_and_b32 v14, 8, v0
    v_lshlrev_b32 v15, 3, v14
    v_lshl_add_u32 v14, v14, 9, v15
    v_lshl_add_u32 v14, v11, 9, v14
    v_and_b32 v15, 1, v11
    v_lshl_add_u32 v14, v15, 5, v14
    v_and_b32 v15, 4, v0
    v_lshl_add_u32 v14, v15, 5, v14
    v_and_b32 v15, 3, v0
    v_lshl_add_u32 v14, v15, 3, v14
    v_and_b32 v15, 1, v0
    v_mul_u32_u24 v15, 0xaaaa, v15
    v_add_u32 v150, 0x4444, v15
    s_waitcnt lgkmcnt(0)
    s_load_dword s6, s[8:9], 0
    s_add_u32 s22, s20, 81920
    v_add_u32 v24, s22, v14
    v_xor_b32 v25, 32, v24
    v_xor_b32 v26, 64, v24
    v_xor_b32 v27, 0x60, v24
    v_and_b32 v13, 1, v0
    v_lshlrev_b32 v13, 6, v13
    v_lshl_add_u32 v13, v11, 4, v13
    v_add_u32 v13, 148736, v13
    v_mov_b32 v63, 0xffff0000
    v_mov_b32 v22, 0
    v_mov_b32 v30, 0
    s_lshl_b32 s31, s29, 11
    s_and_b32 s30, s31, 0xe000
    s_add_u32 s31, s31, s30
    s_add_u32 s31, s31, 1310720
    s_lshl_b32 s30, s18, 9
    s_add_u32 s31, s31, s30
    v_and_b32 v3, 0x1f0, v2
    v_and_b32 v6, 32, v0
    v_lshl_add_u32 v3, v6, 8, v3
    s_waitcnt lgkmcnt(0)
    s_add_u32 s30, s6, 1
    v_mov_b32 v61, s30
    s_mul_i32 s7, s6, 0x9E3779B1
    s_add_u32 s7, s7, 0x7F4A7C15
    s_bitset0_b32 s7, 31
    s_mul_i32 s6, s6, 0x85EBCA6B
    s_add_u32 s6, s6, 0x165667B1
    s_barrier
    s_barrier
    v_lshlrev_b32 v20, 3, v10
    v_lshl_add_u32 v20, v11, 1, v20
    s_lshl_b32 s16, s3, 7
    v_add_u32 v20, s16, v20
    global_load_ushort v60, v20, s[32:33]
    s_waitcnt vmcnt(2)
    buffer_load_dwordx4 v4, s[12:15], s26 offen nt lds
    s_add_u32 s26, s26, 114688
    s_add_u32 m0, m0, 4096
    s_waitcnt vmcnt(2)
    buffer_load_dwordx4 v5, s[12:15], s26 offen nt lds
    s_add_u32 s26, s26, 114688
    s_add_u32 m0, m0, 4096
    s_waitcnt vmcnt(2)
    buffer_load_dwordx4 v4, s[12:15], s26 offen nt lds
    s_add_u32 s26, s26, 114688
    s_add_u32 m0, m0, 4096
    s_waitcnt vmcnt(2)
    buffer_load_dwordx4 v5, s[12:15], s26 offen nt lds
    s_add_u32 s26, s26, 114688
    s_add_u32 m0, m0, 4096
    s_waitcnt vmcnt(2)
    buffer_load_dwordx4 v4, s[12:15], s26 offen nt lds
    s_add_u32 s26, s26, 114688
    s_add_u32 m0, m0, 4096
    s_waitcnt vmcnt(2)
    buffer_load_dwordx4 v5, s[12:15], s26 offen nt lds
    s_add_u32 s26, s26, 114688
    s_add_u32 m0, m0, 4096
    s_waitcnt vmcnt(2)
    buffer_load_dwordx4 v4, s[12:15], s26 offen nt lds
    s_add_u32 s26, s26, 114688
    s_add_u32 m0, m0, 4096
    s_waitcnt vmcnt(2)
    buffer_load_dwordx4 v5, s[12:15], s26 offen nt lds
    s_add_u32 s26, s26, 114688
    s_add_u32 m0, m0, 4096
    s_waitcnt vmcnt(2)
    buffer_load_dwordx4 v4, s[12:15], s26 offen nt lds
    s_add_u32 s26, s26, 114688
    s_add_u32 m0, m0, 4096
    s_nop 0
    buffer_load_dwordx4 v5, s[12:15], s26 offen nt lds
    s_add_u32 s26, s26, 114688
    s_add_u32 m0, m0, 4096
    s_nop 0
    buffer_load_dwordx4 v4, s[12:15], s26 offen nt lds
    s_add_u32 s26, s26, 114688
    s_add_u32 m0, m0, 4096
    s_nop 0
    buffer_load_dwordx4 v5, s[12:15], s26 offen nt lds
    s_add_u32 s26, s26, 114688
    s_add_u32 m0, m0, 4096
    s_nop 0
    buffer_load_dwordx4 v4, s[12:15], s26 offen nt lds
    s_add_u32 s26, s26, 114688
    s_add_u32 m0, m0, 4096
    s_nop 0
    buffer_load_dwordx4 v5, s[12:15], s26 offen nt lds
    s_add_u32 s26, s26, 114688
    s_add_u32 m0, m0, 4096
    s_nop 0
    buffer_load_dwordx4 v4, s[12:15], s26 offen nt lds
    s_add_u32 s26, s26, 114688
    s_add_u32 m0, m0, 4096
    s_nop 0
    buffer_load_dwordx4 v5, s[12:15], s26 offen nt lds
    s_add_u32 s26, s26, 114688
    s_add_u32 m0, m0, 4096
    s_mov_b32 s12, s48
    s_mov_b32 s13, s49
    s_lshl_b32 s26, s29, 16
    s_lshl_b32 s21, s18, 8
    s_add_u32 s26, s26, s21
    s_add_u32 s20, s20, 81920
    s_bfe_u32 s21, s29, 0x20001
    s_lshl_b32 s22, s21, 13
    s_xor_b32 s26, s26, s22
    s_lshl_b32 s22, s21, 10
    s_xor_b32 s20, s20, s22
    v_lshl_add_u32 v4, v8, 10, v9
    v_xor_b32 v5, 64, v4
    s_xor_b32 m0, s20, 0
    s_xor_b32 s21, s26, 0
    s_waitcnt vmcnt(7)
    buffer_load_dwordx4 v4, s[12:15], s21 offen nt lds
    s_xor_b32 m0, s20, 0
    s_xor_b32 s21, s26, 128
    s_add_u32 m0, m0, 8192
    s_waitcnt vmcnt(7)
    buffer_load_dwordx4 v4, s[12:15], s21 offen nt lds
    s_xor_b32 m0, s20, 4096
    s_xor_b32 s21, s26, 32768
    s_waitcnt vmcnt(7)
    buffer_load_dwordx4 v5, s[12:15], s21 offen nt lds
    s_xor_b32 m0, s20, 4096
    s_xor_b32 s21, s26, 32896
    s_add_u32 m0, m0, 8192
    s_waitcnt vmcnt(7)
    buffer_load_dwordx4 v5, s[12:15], s21 offen nt lds
    s_xor_b32 m0, s20, 1024
    s_xor_b32 s21, s26, 8192
    s_waitcnt vmcnt(4)
    s_barrier
    buffer_load_dwordx4 v4, s[12:15], s21 offen nt lds
    s_xor_b32 m0, s20, 1024
    s_xor_b32 s21, s26, 8320
    s_add_u32 m0, m0, 8192
    s_nop 0
    buffer_load_dwordx4 v4, s[12:15], s21 offen nt lds
    s_xor_b32 m0, s20, 5120
    s_xor_b32 s21, s26, 40960
    buffer_load_dwordx4 v5, s[12:15], s21 offen nt lds
    s_xor_b32 m0, s20, 5120
    s_xor_b32 s21, s26, 41088
    s_add_u32 m0, m0, 8192
    s_nop 0
    buffer_load_dwordx4 v5, s[12:15], s21 offen nt lds
    s_xor_b32 m0, s20, 2048
    s_xor_b32 s21, s26, 16384
    buffer_load_dwordx4 v4, s[12:15], s21 offen nt lds
    s_xor_b32 m0, s20, 2048
    s_xor_b32 s21, s26, 16512
    s_add_u32 m0, m0, 8192
    s_nop 0
    buffer_load_dwordx4 v4, s[12:15], s21 offen nt lds
    s_xor_b32 m0, s20, 6144
    s_xor_b32 s21, s26, 49152
    buffer_load_dwordx4 v5, s[12:15], s21 offen nt lds
    s_xor_b32 m0, s20, 6144
    s_xor_b32 s21, s26, 49280
    s_add_u32 m0, m0, 8192
    s_nop 0
    buffer_load_dwordx4 v5, s[12:15], s21 offen nt lds
    s_xor_b32 m0, s20, 3072
    s_xor_b32 s21, s26, 24576
    buffer_load_dwordx4 v4, s[12:15], s21 offen nt lds
    s_xor_b32 m0, s20, 3072
    s_xor_b32 s21, s26, 24704
    s_add_u32 m0, m0, 8192
    s_nop 0
    buffer_load_dwordx4 v4, s[12:15], s21 offen nt lds
    s_xor_b32 m0, s20, 7168
    s_xor_b32 s21, s26, 57344
    buffer_load_dwordx4 v5, s[12:15], s21 offen nt lds
    s_xor_b32 m0, s20, 7168
    s_xor_b32 s21, s26, 57472
    s_add_u32 m0, m0, 8192
    s_nop 0
    buffer_load_dwordx4 v5, s[12:15], s21 offen nt lds
    s_branch L_h3
L_cf:
    s_setprio 0
    s_lshl_b32 s101, s4, 2
    s_add_u32 s29, s29, s101
    s_sub_u32 s29, s29, 4
    v_lshlrev_b32 v20, 3, v10
    v_lshl_add_u32 v20, v11, 1, v20
    s_lshl_b32 s16, s3, 7
    v_add_u32 v20, s16, v20
    global_load_ushort v60, v20, s[32:33]
    s_lshl_b32 s27, s29, 7
    s_lshl_b32 s17, s3, 5
    s_add_u32 s27, s27, s17
    v_lshl_add_u32 v21, v10, 1, s27
    global_load_ushort v61, v21, s[46:47]
    s_cmp_eq_u32 s5, 28
    s_cselect_b32 s28, s4, 8
    s_cmp_eq_u32 s2, 239
    s_cselect_b32 s28, 0, s28
    s_and_b32 s19, s28, 7
    s_lshl_b32 s19, s19, 7
    s_lshl_b32 s26, s3, 3
    s_add_u32 s19, s19, s26
    v_and_b32 v28, 3, v0
    v_lshlrev_b32 v22, 1, v28
    v_lshl_add_u32 v22, v11, 5, v22
    v_add_u32 v22, s19, v22
    global_load_ushort v62, v22, s[50:51]
    v_add_u32 v15, 16384, v15
    v_add_u32 v12, 147456, v12
    v_lshl_add_u32 v21, v10, 1, s17
    v_add_u32 v21, 148736, v21
    v_add_u32 v29, 147456, v22
    v_and_b32 v30, 12, v0
    v_lshlrev_b32 v30, 9, v30
    v_lshl_add_u32 v30, v11, 14, v30
    v_lshl_add_u32 v30, v28, 4, v30
    v_mov_b32 v16, 0x3f803f80
    v_mov_b32 v17, 0x3f803f80
    v_mov_b32 v18, 0x3f803f80
    v_mov_b32 v19, 0x3f803f80
    v_mov_b64 v[24:25], 0
    v_mov_b64 v[26:27], 0
    v_mov_b32 v31, v16
    v_mov_b32 v3, 0
    v_mov_b32 v13, 0
    s_barrier
    ds_read_b32 v4, v1 offset:20
    s_waitcnt lgkmcnt(0)
    v_cmp_eq_u32 vcc, -1, v4
    s_cbranch_vccz L_cf3
    s_mov_b64 exec, 0x5555
    buffer_store_dwordx4 v[56:59], v144, s[8:11], s21 offen sc1
    s_mov_b64 exec, -1
L_cf3:
    ds_read_b64_tr_b16 v[64:65], v15 offset:0
    ds_read_b64_tr_b16 v[66:67], v15 offset:256
    ds_read_b64_tr_b16 v[68:69], v15 offset:2048
    ds_read_b64_tr_b16 v[70:71], v15 offset:2304
    ds_read_b64_tr_b16 v[72:73], v15 offset:8192
    ds_read_b64_tr_b16 v[74:75], v15 offset:8448
    ds_read_b64_tr_b16 v[76:77], v15 offset:10240
    ds_read_b64_tr_b16 v[78:79], v15 offset:10496
    ds_read_b64_tr_b16 v[80:81], v15 offset:16384
    ds_read_b64_tr_b16 v[82:83], v15 offset:16640
    ds_read_b64_tr_b16 v[84:85], v15 offset:18432
    ds_read_b64_tr_b16 v[86:87], v15 offset:18688
    ds_read_b64_tr_b16 v[88:89], v15 offset:24576
    ds_read_b64_tr_b16 v[90:91], v15 offset:24832
    ds_read_b64_tr_b16 v[92:93], v15 offset:26624
    ds_read_b64_tr_b16 v[94:95], v15 offset:26880
    ds_read_b64_tr_b16 v[96:97], v15 offset:32768
    ds_read_b64_tr_b16 v[98:99], v15 offset:33024
    ds_read_b64_tr_b16 v[100:101], v15 offset:34816
    ds_read_b64_tr_b16 v[102:103], v15 offset:35072
    ds_read_b64_tr_b16 v[104:105], v15 offset:40960
    ds_read_b64_tr_b16 v[106:107], v15 offset:41216
    ds_read_b64_tr_b16 v[108:109], v15 offset:43008
    ds_read_b64_tr_b16 v[110:111], v15 offset:43264
    ds_read_b64_tr_b16 v[112:113], v15 offset:49152
    ds_read_b64_tr_b16 v[114:115], v15 offset:49408
    ds_read_b64_tr_b16 v[116:117], v15 offset:51200
    ds_read_b64_tr_b16 v[118:119], v15 offset:51456
    ds_read_b64_tr_b16 v[120:121], v15 offset:57344
    ds_read_b64_tr_b16 v[122:123], v15 offset:57600
    ds_read_b64_tr_b16 v[124:125], v15 offset:59392
    ds_read_b64_tr_b16 v[126:127], v15 offset:59648
    s_waitcnt lgkmcnt(0)
    v_smfmac_f32_16x16x64_bf16 v[24:27], v[16:19], v[64:71], v150
    v_smfmac_f32_16x16x64_bf16 v[24:27], v[16:19], v[72:79], v150
    v_smfmac_f32_16x16x64_bf16 v[24:27], v[16:19], v[80:87], v150
    v_smfmac_f32_16x16x64_bf16 v[24:27], v[16:19], v[88:95], v150
    v_smfmac_f32_16x16x64_bf16 v[24:27], v[16:19], v[96:103], v150
    v_smfmac_f32_16x16x64_bf16 v[24:27], v[16:19], v[104:111], v150
    v_smfmac_f32_16x16x64_bf16 v[24:27], v[16:19], v[112:119], v150
    v_smfmac_f32_16x16x64_bf16 v[24:27], v[16:19], v[120:127], v150
    s_nop 7
    v_add_f32 v27, v24, v25
    v_mov_b64 v[24:25], 0
    s_waitcnt vmcnt(0)
    v_lshlrev_b32 v61, 16, v61
    v_lshlrev_b32 v62, 16, v62
L_h3:
    v_mov_b32 v1, 148608
    ds_read_b32 v1, v1 offset:16
    v_mov_b64 v[128:129], 0
    v_mov_b64 v[130:131], 0
    v_mov_b64 v[132:133], 0
    v_mov_b64 v[134:135], 0
    v_mov_b64 v[136:137], 0
    v_mov_b64 v[138:139], 0
    v_mov_b64 v[140:141], 0
    v_mov_b64 v[142:143], 0
    v_mov_b64 v[152:153], 0
    v_mov_b64 v[154:155], 0
    v_mov_b64 v[156:157], 0
    v_mov_b64 v[158:159], 0
    v_mov_b64 v[160:161], 0
    v_mov_b64 v[162:163], 0
    v_mov_b64 v[164:165], 0
    v_mov_b64 v[166:167], 0
    v_lshlrev_b32 v58, 16, v60
    v_add_u32 v20, 147456, v20
    v_mov_b32 v56, 0x3f80
    v_mov_b32 v57, 1.0
    v_mov_b32 v38, s6
    v_mov_b32 v39, s7
    v_lshlrev_b32 v23, 4, v10
    v_lshl_add_u32 v23, v11, 11, v23
    s_and_b32 s22, s4, 3
    s_lshl_b32 s22, s22, 16
    s_lshl_b32 s23, s3, 8
    s_add_u32 s22, s22, s23
    s_add_u32 s22, s22, 1048576
    s_add_u32 s23, s22, 16384
    s_add_u32 s24, s22, 32768
    s_add_u32 s25, s22, 49152
    s_waitcnt lgkmcnt(0)
    v_add_u32 v23, v23, v1
    v_add_u32 v30, v30, v1
    s_waitcnt vmcnt(3)
    s_barrier
    buffer_load_dwordx4 v[40:43], v23, s[8:11], s22 offen sc1
    buffer_load_dwordx4 v[44:47], v23, s[8:11], s23 offen sc1
    buffer_load_dwordx4 v[48:51], v23, s[8:11], s24 offen sc1
    buffer_load_dwordx4 v[52:55], v23, s[8:11], s25 offen sc1
    s_movk_i32 s58, 20000
    s_cmp_lt_u32 s3, 4
    s_cbranch_scc1 L_nw2
    s_waitcnt vmcnt(4)
    ds_read_b64_tr_b16 v[64:65], v24 offset:0
    ds_read_b64_tr_b16 v[66:67], v24 offset:256
    ds_read_b64_tr_b16 v[68:69], v24 offset:2048
    ds_read_b64_tr_b16 v[70:71], v24 offset:2304
    ds_read_b64_tr_b16 v[72:73], v25 offset:0
    ds_read_b64_tr_b16 v[74:75], v25 offset:256
    ds_read_b64_tr_b16 v[76:77], v25 offset:2048
    ds_read_b64_tr_b16 v[78:79], v25 offset:2304
    ds_read_b64_tr_b16 v[80:81], v26 offset:0
    ds_read_b64_tr_b16 v[82:83], v26 offset:256
    ds_read_b64_tr_b16 v[84:85], v26 offset:2048
    ds_read_b64_tr_b16 v[86:87], v26 offset:2304
    ds_read_b64_tr_b16 v[88:89], v27 offset:0
    ds_read_b64_tr_b16 v[90:91], v27 offset:256
    ds_read_b64_tr_b16 v[92:93], v27 offset:2048
    ds_read_b64_tr_b16 v[94:95], v27 offset:2304
    ds_read_b64_tr_b16 v[96:97], v24 offset:8192
    ds_read_b64_tr_b16 v[98:99], v24 offset:8448
    ds_read_b64_tr_b16 v[100:101], v24 offset:10240
    ds_read_b64_tr_b16 v[102:103], v24 offset:10496
    ds_read_b64_tr_b16 v[104:105], v25 offset:8192
    ds_read_b64_tr_b16 v[106:107], v25 offset:8448
    ds_read_b64_tr_b16 v[108:109], v25 offset:10240
    ds_read_b64_tr_b16 v[110:111], v25 offset:10496
    ds_read_b64_tr_b16 v[112:113], v26 offset:8192
    ds_read_b64_tr_b16 v[114:115], v26 offset:8448
    ds_read_b64_tr_b16 v[116:117], v26 offset:10240
    ds_read_b64_tr_b16 v[118:119], v26 offset:10496
    ds_read_b64_tr_b16 v[120:121], v27 offset:8192
    ds_read_b64_tr_b16 v[122:123], v27 offset:8448
    ds_read_b64_tr_b16 v[124:125], v27 offset:10240
    ds_read_b64_tr_b16 v[126:127], v27 offset:10496
L_nw2:
    s_branch L_poll_24w
L_poll_24:
    s_mov_b64 exec, s[80:81]
    s_cbranch_execz L_sk_26
    buffer_load_dwordx4 v[40:43], v23, s[8:11], s22 offen sc1
L_sk_26:
    s_mov_b64 exec, s[82:83]
    s_cbranch_execz L_sk_27
    buffer_load_dwordx4 v[44:47], v23, s[8:11], s23 offen sc1
L_sk_27:
    s_mov_b64 exec, s[84:85]
    s_cbranch_execz L_sk_28
    buffer_load_dwordx4 v[48:51], v23, s[8:11], s24 offen sc1
L_sk_28:
    s_mov_b64 exec, s[86:87]
    s_cbranch_execz L_sk_29
    buffer_load_dwordx4 v[52:55], v23, s[8:11], s25 offen sc1
L_sk_29:
    s_mov_b64 exec, -1
    s_sub_u32 s58, s58, 1
    s_cbranch_scc1 L_done_25t
L_poll_24w:
    s_waitcnt vmcnt(0)
    v_cmp_ne_u64 s[80:81], s[6:7], v[42:43]
    v_cmp_ne_u64 s[82:83], s[6:7], v[46:47]
    v_cmp_ne_u64 s[84:85], s[6:7], v[50:51]
    v_cmp_ne_u64 s[86:87], s[6:7], v[54:55]
    s_or_b64 s[56:57], s[80:81], s[82:83]
    s_or_b64 s[56:57], s[56:57], s[84:85]
    s_or_b64 s[56:57], s[56:57], s[86:87]
    s_cbranch_scc1 L_poll_24
L_done_25:
    v_lshlrev_b32 v32, 16, v40
    v_lshlrev_b32 v34, 16, v41
    v_and_b32 v33, v63, v40
    v_and_b32 v35, v63, v41
    v_dot2c_f32_bf16 v32, v44, v56
    v_dot2c_f32_bf16 v34, v45, v56
    v_dot2c_f32_bf16 v33, v44, v57
    v_dot2c_f32_bf16 v35, v45, v57
    v_dot2c_f32_bf16 v32, v48, v56
    v_dot2c_f32_bf16 v34, v49, v56
    v_dot2c_f32_bf16 v33, v48, v57
    v_dot2c_f32_bf16 v35, v49, v57
    v_dot2c_f32_bf16 v32, v52, v56
    v_dot2c_f32_bf16 v34, v53, v56
    v_dot2c_f32_bf16 v33, v52, v57
    v_dot2c_f32_bf16 v35, v53, v57
    s_nop 0
    v_permlane32_swap_b32 v32, v34
    s_nop 0
    v_permlane32_swap_b32 v33, v35
    v_add_f32 v32, v32, v34
    v_add_f32 v33, v33, v35
    s_nop 1
    v_permlane16_swap_b32 v32, v33
    v_add_f32 v32, v32, v33
    v_cvt_pk_bf16_f32 v32, 0, v32
    v_add_f32 v32, v32, v58
    v_cvt_pk_bf16_f32 v32, v32, v32
    ds_write_b16 v20, v32
    s_cmp_ge_u32 s3, 4
    s_waitcnt lgkmcnt(0)
    s_barrier
    s_cbranch_scc1 L_f2
    ds_read_b128 v[16:19], v12
    ds_read_u16 v60, v29
    s_waitcnt lgkmcnt(1)
    v_dot2c_f32_bf16 v24, v16, v31
    v_dot2c_f32_bf16 v25, v16, v16
    v_dot2c_f32_bf16 v24, v17, v31
    v_dot2c_f32_bf16 v25, v17, v17
    v_dot2c_f32_bf16 v24, v18, v31
    v_dot2c_f32_bf16 v25, v18, v18
    v_dot2c_f32_bf16 v24, v19, v31
    v_dot2c_f32_bf16 v25, v19, v19
    v_smfmac_f32_16x16x64_bf16 v[128:131], v[16:19], v[64:71], v150
    v_smfmac_f32_16x16x64_bf16 v[136:139], v[16:19], v[80:87], v150
    v_smfmac_f32_16x16x64_bf16 v[152:155], v[16:19], v[96:103], v150
    v_permlane32_swap_b32 v24, v25
    v_add_f32 v24, v24, v25
    v_smfmac_f32_16x16x64_bf16 v[160:163], v[16:19], v[112:119], v150
    v_smfmac_f32_16x16x64_bf16 v[132:135], v[16:19], v[72:79], v150
    v_add_f32_dpp v24, v24, v24 quad_perm:[1,0,3,2] row_mask:0xf bank_mask:0xf
    v_smfmac_f32_16x16x64_bf16 v[140:143], v[16:19], v[88:95], v150
    v_add_f32 v32, v128, v129
    v_add_f32_dpp v24, v24, v24 quad_perm:[2,3,0,1] row_mask:0xf bank_mask:0xf
    v_smfmac_f32_16x16x64_bf16 v[156:159], v[16:19], v[104:111], v150
    v_add_f32_dpp v32, v136, v137 quad_perm:[0,1,2,3] row_mask:0x2 bank_mask:0xf
    v_add_f32_dpp v24, v24, v24 row_half_mirror row_mask:0xf bank_mask:0xf
    v_smfmac_f32_16x16x64_bf16 v[164:167], v[16:19], v[120:127], v150
    v_add_f32_dpp v32, v152, v153 quad_perm:[0,1,2,3] row_mask:0x4 bank_mask:0xf
    v_add_f32_dpp v24, v24, v24 row_mirror row_mask:0xf bank_mask:0xf
    v_add_f32 v33, v134, v135
    v_add_f32_dpp v32, v160, v161 quad_perm:[0,1,2,3] row_mask:0x8 bank_mask:0xf
    v_permlane16_swap_b32 v24, v25
    v_add_f32_dpp v33, v142, v143 quad_perm:[0,1,2,3] row_mask:0x2 bank_mask:0xf
    v_add_f32 v24, v24, v25
    v_mul_f32 v24, 0x3b000000, v24
    v_add_f32_dpp v33, v158, v159 quad_perm:[0,1,2,3] row_mask:0x4 bank_mask:0xf
    s_mov_b32 s30, 0x3727c5ac
    v_permlane32_swap_b32 v24, v25
    v_add_f32_dpp v33, v166, v167 quad_perm:[0,1,2,3] row_mask:0x8 bank_mask:0xf
    v_fma_f32 v25, -v24, v24, v25
    v_add_f32 v32, v32, v33
    v_max_f32 v25, 0, v25
    v_cvt_pk_bf16_f32 v25, 0, v25
    v_permlane32_swap_b32 v32, v33
    v_add_f32 v25, s30, v25
    v_add_f32 v32, v32, v33
    v_cvt_pk_bf16_f32 v25, 0, v25
    v_sqrt_f32 v25, v25
    v_permlane16_swap_b32 v32, v33
    v_cvt_pk_bf16_f32 v25, 0, v25
    v_rcp_f32 v25, v25
    v_cvt_pk_bf16_f32 v24, 0, v24
    v_add_f32 v32, v32, v33
    v_fma_f32 v32, -v24, v27, v32
    v_fma_f32 v32, v32, v25, v61
    v_max_f32 v32, 0, v32
    v_mul_f32 v32, v32, v32
    v_cvt_pk_bf16_f32 v32, v32, v32
    s_mov_b64 exec, 0xffff
    ds_write_b16 v21, v32
    s_mov_b64 exec, -1
    s_cmp_ge_u32 s28, 8
    s_waitcnt lgkmcnt(0)
    s_barrier
    s_cbranch_scc1 L_end
    s_lshl_b32 s26, s28, 8
    s_lshl_b32 s27, s3, 6
    s_add_u32 s26, s26, s27
    s_add_u32 s26, s26, 1310720
    s_add_u32 s27, s26, 65536
    v_lshlrev_b32 v60, 16, v60
    v_mov_b64 v[52:53], 0
    v_mov_b32 v54, s6
    v_mov_b32 v55, s7
    s_mov_b32 s24, -1
    s_mov_b32 s25, 0xffff
    s_mov_b32 s20, 0x000f000f
    s_mov_b32 s21, 0x000f000f
    s_barrier
    buffer_load_dwordx4 v[44:47], v30, s[8:11], s26 offen sc1
    s_mov_b64 exec, s[24:25]
    buffer_load_dwordx4 v[52:55], v30, s[8:11], s27 offen sc1
    s_mov_b64 exec, -1
    s_movk_i32 s58, 20000
    s_branch L_poll_30w
L_poll_30:
    s_mov_b64 exec, s[80:81]
    s_cbranch_execz L_sk_32
    buffer_load_dwordx4 v[44:47], v30, s[8:11], s26 offen sc1
L_sk_32:
    s_mov_b64 exec, s[82:83]
    s_cbranch_execz L_sk_33
    buffer_load_dwordx4 v[52:55], v30, s[8:11], s27 offen sc1
L_sk_33:
    s_mov_b64 exec, -1
    s_sub_u32 s58, s58, 1
    s_cbranch_scc1 L_done_31t
L_poll_30w:
    s_waitcnt vmcnt(0)
    v_cmp_ne_u64 s[80:81], s[6:7], v[46:47]
    v_cmp_ne_u64 s[82:83], s[6:7], v[54:55]
    s_or_b64 s[56:57], s[80:81], s[82:83]
    s_cbranch_scc1 L_poll_30
L_done_31:
    v_lshlrev_b32 v48, 16, v44
    v_lshlrev_b32 v50, 16, v45
    v_and_b32 v49, v63, v44
    v_and_b32 v51, v63, v45
    v_dot2c_f32_bf16 v48, v52, v56
    v_dot2c_f32_bf16 v50, v53, v56
    v_dot2c_f32_bf16 v49, v52, v57
    v_dot2c_f32_bf16 v51, v53, v57
    s_nop 0
    v_permlane32_swap_b32 v48, v50
    s_nop 0
    v_permlane32_swap_b32 v49, v51
    v_add_f32 v48, v48, v50
    v_add_f32 v49, v49, v51
    s_nop 1
    v_permlane16_swap_b32 v48, v49
    v_add_f32 v48, v48, v49
    s_nop 1
    v_add_f32_dpp v48, v48, v48 row_ror:4 row_mask:0xf bank_mask:0xf
    s_nop 1
    v_add_f32_dpp v48, v48, v48 row_ror:8 row_mask:0xf bank_mask:0xf
    v_cvt_pk_bf16_f32 v48, 0, v48
    v_add_f32 v48, v48, v62
    v_cvt_pk_bf16_f32 v48, 0, v48
    v_add_f32 v48, v48, v60
    v_cvt_pk_bf16_f32 v48, v48, v48
    s_mov_b64 exec, s[20:21]
    global_store_short v22, v48, s[52:53]
    s_endpgm
L_f2:
    s_cmp_lg_u32 s3, 5
    s_cbranch_scc1 L_f4
    s_cmp_lg_u32 s2, 251
    s_cbranch_scc1 L_f3
    s_mov_b64 exec, 1
    buffer_store_dword v61, v0, s[8:11], 0 offen sc1
    s_mov_b64 exec, -1
L_f3:
    s_cmp_lg_u32 s5, 30
    s_cbranch_scc1 L_f4
    buffer_wbl2 sc1
L_f4:
    s_barrier
    ds_read_b128 v[16:19], v13
    s_waitcnt lgkmcnt(0)
    v_smfmac_f32_16x16x64_bf16 v[128:131], v[16:19], v[64:71], v150
    v_smfmac_f32_16x16x64_bf16 v[132:135], v[16:19], v[72:79], v150
    v_smfmac_f32_16x16x64_bf16 v[136:139], v[16:19], v[80:87], v150
    v_smfmac_f32_16x16x64_bf16 v[140:143], v[16:19], v[88:95], v150
    v_smfmac_f32_16x16x64_bf16 v[152:155], v[16:19], v[96:103], v150
    v_smfmac_f32_16x16x64_bf16 v[156:159], v[16:19], v[104:111], v150
    v_smfmac_f32_16x16x64_bf16 v[160:163], v[16:19], v[112:119], v150
    s_nop 1
    v_add_f32 v32, v128, v129
    v_add_f32 v33, v132, v133
    v_smfmac_f32_16x16x64_bf16 v[164:167], v[16:19], v[120:127], v150
    v_add_f32 v34, v136, v137
    v_add_f32 v35, v140, v141
    v_add_f32_dpp v32, v152, v153 quad_perm:[0,1,2,3] row_mask:0xa bank_mask:0xf
    v_add_f32_dpp v33, v156, v157 quad_perm:[0,1,2,3] row_mask:0xa bank_mask:0xf
    v_add_f32_dpp v34, v160, v161 quad_perm:[0,1,2,3] row_mask:0xa bank_mask:0xf
    s_nop 2
    v_add_f32_dpp v35, v164, v165 quad_perm:[0,1,2,3] row_mask:0xa bank_mask:0xf
    v_cvt_pk_bf16_f32 v36, v32, v33
    v_cvt_pk_bf16_f32 v37, v34, v35
    buffer_store_dwordx4 v[36:39], v3, s[8:11], s31 offen sc1
    s_waitcnt vmcnt(0)
    s_barrier
    s_endpgm
L_done_21t:
    s_waitcnt vmcnt(0)
    s_branch L_done_21
L_done_25t:
    s_waitcnt vmcnt(0)
    s_branch L_done_25
L_done_31t:
    s_waitcnt vmcnt(0)
    s_branch L_done_31
L_end:
    s_endpgm
    .fill 384, 4, 0xbf810000
.section .rodata,"a"
.p2align 6
.amdhsa_kernel sequential_preLN__sliding_block_cached__dense_activation_squared_relu__decode_kernel
  .amdhsa_next_free_vgpr 168
  .amdhsa_next_free_sgpr 102
  .amdhsa_accum_offset 168
  .amdhsa_group_segment_fixed_size 0
  .amdhsa_kernarg_size 104
  .amdhsa_user_sgpr_count 2
  .amdhsa_user_sgpr_kernarg_segment_ptr 1
  .amdhsa_system_sgpr_workgroup_id_x 1
  .amdhsa_float_denorm_mode_32 3
.end_amdhsa_kernel
```
